```python
import torch

def _softmax(x, axis=-1):
    return torch.softmax(x, dim=axis)

def _gelu(x):
    return torch.nn.functional.gelu(x, approximate='tanh')

def _silu(x):
    return torch.nn.functional.silu(x)

def _sigmoid(x):
    return torch.sigmoid(x)

def _layernorm(x, axis=-1, eps=1e-05):
    m = x.mean(dim=axis, keepdim=True)
    v = x.var(dim=axis, keepdim=True, unbiased=False)
    return (x - m) / torch.sqrt(v + eps)

def _scatter_add(tgt, idx, src, axis=0):
    return tgt.clone().index_add_(axis, idx, src)

def _segment_sum(src, seg, n):
    out = torch.zeros((n,) + src.shape[1:], dtype=src.dtype)
    return out.index_add_(0, seg, src)

def _pad(x, pw):
    flat = tuple((v for pair in reversed(pw) for v in pair))
    return torch.nn.functional.pad(x, flat)
kernel_name = 'adaLN_cond__gqa_block_cached__swiglu_ffn__decode'

def setup_inputs():

    _w = lambda a: (lambda t: t.to(torch.bfloat16) if t.is_floating_point() else t)(torch.as_tensor(a))

    def _A_setup():
        B, Sq, D = (1, 1, 448)
        Hq, Hkv, Sk, Dh = (16, 8, 32768, 256)
        assert Hq % Hkv == 0, (Hq, Hkv)
        return {'x': _w((lambda *s: torch.randn(*s, dtype=torch.bfloat16) * 0.1)(B, Sq, D)), 'k_cache': _w((lambda *s: torch.randn(*s, dtype=torch.bfloat16) * 0.8)(B, Hkv, Sk, Dh)), 'v_cache': _w((lambda *s: torch.randn(*s, dtype=torch.bfloat16) * 0.8)(B, Hkv, Sk, Dh)), 'wq': _w((lambda *s: torch.randn(*s, dtype=torch.bfloat16) * 0.8)(D, Hq * Dh) * D ** (-0.5)), 'wo': _w((lambda *s: torch.randn(*s, dtype=torch.bfloat16) * 0.8)(Hq * Dh, D) * (Hq * Dh) ** (-0.5))}
    _A_in = _A_setup()

    def _B_setup():
        B, S, D, F = (1, 1, 448, 1792)
        return {'x': _w((lambda *s: torch.randn(*s, dtype=torch.bfloat16) * 0.1)(B, S, D)), 'w_gate': _w((lambda *s: torch.randn(*s, dtype=torch.bfloat16) * 0.1)(D, F)), 'w_up': _w((lambda *s: torch.randn(*s, dtype=torch.bfloat16) * 0.1)(D, F)), 'w_down': _w((lambda *s: torch.randn(*s, dtype=torch.bfloat16) * 0.1)(F, D))}
    _B_in = _B_setup()
    return {'A_x': _A_in['x'], 'A_k_cache': _A_in['k_cache'], 'A_v_cache': _A_in['v_cache'], 'A_wq': _A_in['wq'], 'A_wo': _A_in['wo'], 'B_x': _B_in['x'], 'B_w_gate': _B_in['w_gate'], 'B_w_up': _B_in['w_up'], 'B_w_down': _B_in['w_down'], 'c': _w((lambda *s: torch.randn(*s, dtype=torch.bfloat16) * 0.4)(1, 448) * 8.0), 'w_mod': _w((lambda *s: torch.randn(*s, dtype=torch.bfloat16) * 0.4)(448, 6 * 448) * 448 ** (-0.5) * 8.0)}

def reference(A_x, A_k_cache, A_v_cache, A_wq, A_wo, B_x, B_w_gate, B_w_up, B_w_down, c, w_mod):

    def _A_ref(x, k_cache, v_cache, wq, wo):
        B, Sq, D = x.shape
        Hq, Dh = (16, 256)
        Hkv = k_cache.shape[1]
        rep = Hq // Hkv
        q = (lambda x, *d: x.permute(*d))((x @ wq).reshape(B, Sq, Hq, Dh), 0, 2, 1, 3)
        k = (lambda x, n, axis: torch.repeat_interleave(x, n, dim=axis))(k_cache, rep, axis=1)
        v = (lambda x, n, axis: torch.repeat_interleave(x, n, dim=axis))(v_cache, rep, axis=1)
        scores = torch.einsum('bhqd,bhkd->bhqk', q, k) * Dh ** (-0.5)
        p = _softmax(scores, axis=-1)
        o = torch.einsum('bhqk,bhkd->bhqd', p, v)
        return (lambda x, *d: x.permute(*d))(o, 0, 2, 1, 3).reshape(B, Sq, Hq * Dh) @ wo

    def _B_ref(x, w_gate, w_up, w_down):
        g = _silu(x @ w_gate)
        u = x @ w_up
        return g * u @ w_down
    x = A_x
    mod = (_silu(c) @ w_mod).reshape(c.shape[0], 6, 1, -1)
    sa, ca, ga, sb, cb, gb = (mod[:, 0].clone(), mod[:, 1].clone(), mod[:, 2].clone(), mod[:, 3].clone(), mod[:, 4].clone(), mod[:, 5].clone())
    h = _layernorm(x, axis=-1) * (1 + ca) + sa
    x = x + ga * _A_ref(h, A_k_cache, A_v_cache, A_wq, A_wo)
    h = _layernorm(x, axis=-1) * (1 + cb) + sb
    x = x + gb * _B_ref(h, B_w_gate, B_w_up, B_w_down)
    return x
```

```asm
; @launch grid=(256,1,1) block=(512,1,1) lds=143360
.amdgcn_target "amdgcn-amd-amdhsa--gfx950"
.text
.set CODE_Q, 9216
.globl adaLN_cond__gqa_block_cached__swiglu_ffn__decode_kernel
.p2align 8
.type adaLN_cond__gqa_block_cached__swiglu_ffn__decode_kernel,@function
adaLN_cond__gqa_block_cached__swiglu_ffn__decode_kernel:
s_load_dwordx16 s[32:47], s[0:1], 0
s_load_dwordx8 s[48:55], s[0:1], 64
s_load_dwordx4 s[56:59], s[0:1], 96
v_readfirstlane_b32 s3, v0
v_and_b32 v0, 63, v0
v_mov_b32 v7, 0
v_lshlrev_b32 v2, 2, v0
ds_write_b32 v2, v7
s_and_b32 s4, s2, 7
s_lshr_b32 s5, s2, 3
v_lshrrev_b32 v5, 4, v0
v_and_b32 v1, 3, v0
v_lshlrev_b32 v1, 4, v1
s_lshl_b32 s6, s4, 5
s_add_u32 s6, s6, s5
v_lshl_add_u32 v1, v5, 6, v1
v_and_b32 v6, 12, v0
s_lshl_b32 s28, s3, 6
s_lshr_b32 s3, s3, 6
v_lshl_add_u32 v1, v6, 7, v1
s_mov_b32 s11, 0x20000
s_mul_i32 s7, s4, 96
s_add_u32 s7, s7, s5
s_lshl_b32 s7, s7, 14
s_add_u32 s28, s28, s7
s_lshl_b32 s7, s4, 24
s_bfm_b32 s10, 1, 24
s_cmpk_ge_u32 s2, 256
s_cbranch_scc1 L_exit
s_cmp_ge_u32 s3, 4
s_waitcnt lgkmcnt(0)
s_barrier
s_cbranch_scc1 L_helper
s_add_u32 s8, s34, s7
s_addc_u32 s9, s35, 0
buffer_load_dwordx4 v[36:39], v1, s[8:11], s28 offen offset:0 nt
buffer_load_dwordx4 v[40:43], v1, s[8:11], s28 offen offset:256 nt
buffer_load_dwordx4 v[44:47], v1, s[8:11], s28 offen offset:2048 nt
buffer_load_dwordx4 v[48:51], v1, s[8:11], s28 offen offset:2304 nt
s_add_u32 s28, s28, 0x80000
s_bitset0_b32 s28, 24
buffer_load_dwordx4 v[52:55], v1, s[8:11], s28 offen offset:0 nt
buffer_load_dwordx4 v[56:59], v1, s[8:11], s28 offen offset:256 nt
buffer_load_dwordx4 v[60:63], v1, s[8:11], s28 offen offset:2048 nt
s_waitcnt vmcnt(4)
buffer_load_dwordx4 v[64:67], v1, s[8:11], s28 offen offset:2304 nt
s_add_u32 s28, s28, 0x80000
s_bitset0_b32 s28, 24
s_waitcnt vmcnt(4)
buffer_load_dwordx4 v[68:71], v1, s[8:11], s28 offen offset:0 nt
s_waitcnt vmcnt(4)
buffer_load_dwordx4 v[72:75], v1, s[8:11], s28 offen offset:256 nt
s_waitcnt vmcnt(4)
buffer_load_dwordx4 v[76:79], v1, s[8:11], s28 offen offset:2048 nt
s_waitcnt vmcnt(4)
buffer_load_dwordx4 v[80:83], v1, s[8:11], s28 offen offset:2304 nt
s_add_u32 s28, s28, 0x80000
s_bitset0_b32 s28, 24
s_waitcnt vmcnt(4)
buffer_load_dwordx4 v[84:87], v1, s[8:11], s28 offen offset:0 nt
s_waitcnt vmcnt(4)
buffer_load_dwordx4 v[88:91], v1, s[8:11], s28 offen offset:256 nt
s_waitcnt vmcnt(4)
buffer_load_dwordx4 v[92:95], v1, s[8:11], s28 offen offset:2048 nt
s_waitcnt vmcnt(4)
buffer_load_dwordx4 v[96:99], v1, s[8:11], s28 offen offset:2304 nt
s_add_u32 s28, s28, 0x80000
s_bitset0_b32 s28, 24
s_waitcnt vmcnt(4)
buffer_load_dwordx4 v[100:103], v1, s[8:11], s28 offen offset:0 nt
s_waitcnt vmcnt(4)
buffer_load_dwordx4 v[104:107], v1, s[8:11], s28 offen offset:256 nt
s_waitcnt vmcnt(4)
buffer_load_dwordx4 v[108:111], v1, s[8:11], s28 offen offset:2048 nt
s_waitcnt vmcnt(4)
buffer_load_dwordx4 v[112:115], v1, s[8:11], s28 offen offset:2304 nt
s_add_u32 s28, s28, 0x80000
s_bitset0_b32 s28, 24
s_waitcnt vmcnt(4)
buffer_load_dwordx4 v[116:119], v1, s[8:11], s28 offen offset:0 nt
s_waitcnt vmcnt(4)
buffer_load_dwordx4 v[120:123], v1, s[8:11], s28 offen offset:256 nt
s_waitcnt vmcnt(4)
buffer_load_dwordx4 v[124:127], v1, s[8:11], s28 offen offset:2048 nt
s_waitcnt vmcnt(4)
buffer_load_dwordx4 v[128:131], v1, s[8:11], s28 offen offset:2304 nt
s_add_u32 s28, s28, 0x80000
s_bitset0_b32 s28, 24
v_lshrrev_b32 v6, 2, v6
s_add_u32 s12, s36, s7
s_addc_u32 s13, s37, 0
s_mov_b32 s14, s10
s_mov_b32 s15, 0x20000
s_and_b32 s24, s3, 1
s_lshr_b32 s25, s3, 1
s_lshl_b32 s29, s25, 13
s_lshl_b32 s7, s24, 8
s_add_u32 s29, s29, s7
s_mul_i32 s7, s4, 96
s_add_u32 s7, s7, s5
s_and_b32 s7, s7, 1023
s_lshl_b32 s7, s7, 14
s_add_u32 s29, s29, s7
v_and_b32 v2, 15, v0
v_lshlrev_b32 v2, 4, v2
v_lshl_add_u32 v2, v5, 9, v2
s_lshl_b32 s7, s25, 11
s_add_u32 s7, s7, 12288
v_bfe_u32 v4, v0, 3, 1
v_mul_u32_u24 v4, 4160, v4
v_lshl_add_u32 v4, v5, 4, v4
v_add_u32 v4, s7, v4
s_lshl_b32 s26, s24, 3
s_add_u32 s7, s7, s26
v_and_b32 v3, 1, v5
v_mul_u32_u24 v3, 4160, v3
v_lshl_add_u32 v3, v6, 4, v3
v_lshrrev_b32 v12, 5, v0
v_lshl_add_u32 v3, v12, 2, v3
v_add_u32 v3, s7, v3
v_bfe_u32 v12, v0, 2, 1
v_lshlrev_b32 v12, 9, v12
v_lshl_add_u32 v12, v5, 6, v12
v_and_b32 v13, 3, v0
v_lshl_add_u32 v12, v13, 4, v12
s_mul_i32 s63, s3, 28672
s_add_u32 s63, s63, 28672
v_lshl_add_u32 v252, v0, 4, s63
s_sub_u32 s63, s63, 4096
s_mov_b32 s16, s58
s_mov_b32 s17, s59
s_mov_b32 s18, 957440
s_mov_b32 s19, 0x20000
v_and_b32 v6, 1, v0
v_lshlrev_b32 v6, 4, v6
v_mov_b32 v5, 0xffff
v_lshlrev_b32 v5, v6, v5
v_bfe_u32 v6, v0, 1, 2
v_cmp_eq_u32 vcc, 0, v6
s_nop 1
v_cndmask_b32 v8, 0, v5, vcc
v_cmp_eq_u32 vcc, 1, v6
s_nop 1
v_cndmask_b32 v9, 0, v5, vcc
v_cmp_eq_u32 vcc, 2, v6
s_nop 1
v_cndmask_b32 v10, 0, v5, vcc
v_cmp_eq_u32 vcc, 3, v6
s_nop 1
v_cndmask_b32 v11, 0, v5, vcc
s_mov_b32 s61, 1
s_cmp_lt_u32 s5, 14
s_cbranch_scc1 L_r_1
s_sub_u32 s62, s5, 14
s_lshl_b32 s62, s62, 3
s_add_u32 s62, s62, s4
s_cmp_lt_u32 s62, 28
s_cselect_b32 s61, 2, 0
s_cmp_ge_u32 s5, 24
s_cselect_b32 s61, 3, s61
s_cmp_eq_u32 s5, 18
s_cselect_b32 s61, 4, s61
s_sub_u32 s7, s62, 40
s_cmp_lt_u32 s7, 28
s_cselect_b32 s61, 5, s61
L_r_1:
s_cmp_eq_u32 s61, 2
s_cselect_b32 s64, 1, 0
s_mov_b32 s68, s64
s_cmp_eq_u32 s61, 5
s_cselect_b32 s64, 1, s64
s_mov_b32 s69, s62
s_mov_b32 s60, 0
s_cmp_ge_u32 s2, 150
s_cselect_b32 s7, 30, 0
s_cmp_ge_u32 s2, 178
s_cselect_b32 s7, 40, s7
s_cmp_ge_u32 s2, 242
s_cselect_b32 s7, 40, s7
s_add_u32 s61, s7, 48
s_waitcnt vmcnt(4)
buffer_load_dwordx4 v[132:135], v1, s[8:11], s28 offen offset:0 nt
s_waitcnt vmcnt(4)
buffer_load_dwordx4 v[136:139], v1, s[8:11], s28 offen offset:256 nt
s_waitcnt vmcnt(4)
buffer_load_dwordx4 v[140:143], v1, s[8:11], s28 offen offset:2048 nt
s_waitcnt vmcnt(4)
buffer_load_dwordx4 v[144:147], v1, s[8:11], s28 offen offset:2304 nt
s_add_u32 s28, s28, 0x80000
s_bitset0_b32 s28, 24
s_waitcnt vmcnt(4)
buffer_load_dwordx4 v[148:151], v1, s[8:11], s28 offen offset:0 nt
s_waitcnt vmcnt(4)
buffer_load_dwordx4 v[152:155], v1, s[8:11], s28 offen offset:256 nt
s_waitcnt vmcnt(4)
buffer_load_dwordx4 v[156:159], v1, s[8:11], s28 offen offset:2048 nt
s_waitcnt vmcnt(4)
buffer_load_dwordx4 v[160:163], v1, s[8:11], s28 offen offset:2304 nt
s_add_u32 s28, s28, 0x80000
s_bitset0_b32 s28, 24
s_waitcnt vmcnt(4)
buffer_load_dwordx4 v[164:167], v1, s[8:11], s28 offen offset:0 nt
s_waitcnt vmcnt(4)
buffer_load_dwordx4 v[168:171], v1, s[8:11], s28 offen offset:256 nt
s_waitcnt vmcnt(4)
buffer_load_dwordx4 v[172:175], v1, s[8:11], s28 offen offset:2048 nt
s_waitcnt vmcnt(4)
buffer_load_dwordx4 v[176:179], v1, s[8:11], s28 offen offset:2304 nt
s_add_u32 s28, s28, 0x80000
s_bitset0_b32 s28, 24
s_waitcnt vmcnt(4)
buffer_load_dwordx4 v[180:183], v1, s[8:11], s28 offen offset:0 nt
s_waitcnt vmcnt(4)
buffer_load_dwordx4 v[184:187], v1, s[8:11], s28 offen offset:256 nt
s_waitcnt vmcnt(4)
buffer_load_dwordx4 v[188:191], v1, s[8:11], s28 offen offset:2048 nt
s_waitcnt vmcnt(4)
buffer_load_dwordx4 v[192:195], v1, s[8:11], s28 offen offset:2304 nt
s_add_u32 s28, s28, 0x80000
s_bitset0_b32 s28, 24
s_waitcnt vmcnt(4)
buffer_load_dwordx4 v[196:199], v1, s[8:11], s28 offen offset:0 nt
s_waitcnt vmcnt(4)
buffer_load_dwordx4 v[200:203], v1, s[8:11], s28 offen offset:256 nt
s_waitcnt vmcnt(4)
buffer_load_dwordx4 v[204:207], v1, s[8:11], s28 offen offset:2048 nt
s_waitcnt vmcnt(4)
buffer_load_dwordx4 v[208:211], v1, s[8:11], s28 offen offset:2304 nt
s_add_u32 s28, s28, 0x80000
s_bitset0_b32 s28, 24
s_waitcnt vmcnt(4)
buffer_load_dwordx4 v[212:215], v1, s[8:11], s28 offen offset:0 nt
s_waitcnt vmcnt(4)
buffer_load_dwordx4 v[216:219], v1, s[8:11], s28 offen offset:256 nt
s_waitcnt vmcnt(4)
buffer_load_dwordx4 v[220:223], v1, s[8:11], s28 offen offset:2048 nt
s_waitcnt vmcnt(4)
buffer_load_dwordx4 v[224:227], v1, s[8:11], s28 offen offset:2304 nt
s_add_u32 s28, s28, 0x80000
s_bitset0_b32 s28, 24
s_cmpk_gt_u32 s61, 48
s_cbranch_scc1 L_b_2
s_waitcnt vmcnt(4)
L_b_2:
buffer_load_dwordx4 v[228:231], v1, s[8:11], s28 offen offset:0 nt
s_cmpk_gt_u32 s61, 49
s_cbranch_scc1 L_b_3
s_waitcnt vmcnt(4)
L_b_3:
s_waitcnt vmcnt(5)
buffer_load_dwordx4 v[232:235], v1, s[8:11], s28 offen offset:256 nt
s_cmpk_gt_u32 s61, 50
s_cbranch_scc1 L_b_4
s_waitcnt vmcnt(4)
L_b_4:
s_waitcnt vmcnt(5)
buffer_load_dwordx4 v[236:239], v1, s[8:11], s28 offen offset:2048 nt
s_cmpk_gt_u32 s61, 51
s_cbranch_scc1 L_b_5
s_waitcnt vmcnt(4)
L_b_5:
s_waitcnt vmcnt(5)
buffer_load_dwordx4 v[240:243], v1, s[8:11], s28 offen offset:2304 nt
s_add_u32 s28, s28, 0x80000
s_bitset0_b32 s28, 24
s_cmpk_gt_u32 s61, 52
s_cbranch_scc1 L_b_6
s_waitcnt vmcnt(4)
L_b_6:
s_waitcnt vmcnt(5)
buffer_load_dwordx4 v[244:247], v1, s[8:11], s28 offen offset:0 nt
s_cmpk_gt_u32 s61, 53
s_cbranch_scc1 L_b_7
s_waitcnt vmcnt(4)
L_b_7:
s_waitcnt vmcnt(5)
buffer_load_dwordx4 v[248:251], v1, s[8:11], s28 offen offset:256 nt
s_add_u32 m0, s63, 2048
s_cmpk_gt_u32 s61, 54
s_cbranch_scc1 L_b_8
s_waitcnt vmcnt(4)
L_b_8:
s_waitcnt vmcnt(5)
buffer_load_dwordx4 v1, s[8:11], s28 offen offset:2048 nt lds
s_add_u32 m0, s63, 2816
s_cmpk_gt_u32 s61, 55
s_cbranch_scc1 L_b_9
s_waitcnt vmcnt(4)
L_b_9:
s_waitcnt vmcnt(5)
buffer_load_dwordx4 v1, s[8:11], s28 offen offset:2304 nt lds
s_add_u32 s28, s28, 0x80000
s_bitset0_b32 s28, 24
s_add_u32 m0, s63, 6144
s_cmpk_gt_u32 s61, 56
s_cbranch_scc1 L_b_10
s_waitcnt vmcnt(4)
L_b_10:
s_waitcnt vmcnt(5)
buffer_load_dwordx4 v1, s[8:11], s28 offen offset:0 nt lds
s_add_u32 m0, s63, 6912
s_cmpk_gt_u32 s61, 57
s_cbranch_scc1 L_b_11
s_waitcnt vmcnt(4)
L_b_11:
s_waitcnt vmcnt(5)
buffer_load_dwordx4 v1, s[8:11], s28 offen offset:256 nt lds
s_add_u32 m0, s63, 6144
s_cmpk_gt_u32 s61, 58
s_cbranch_scc1 L_b_12
s_waitcnt vmcnt(4)
L_b_12:
s_waitcnt vmcnt(5)
buffer_load_dwordx4 v1, s[8:11], s28 offen offset:2048 nt lds
s_add_u32 m0, s63, 6912
s_cmpk_gt_u32 s61, 59
s_cbranch_scc1 L_b_13
s_waitcnt vmcnt(4)
L_b_13:
s_waitcnt vmcnt(5)
buffer_load_dwordx4 v1, s[8:11], s28 offen offset:2304 nt lds
s_add_u32 s28, s28, 0x80000
s_bitset0_b32 s28, 24
s_add_u32 m0, s63, 10240
s_cmpk_gt_u32 s61, 60
s_cbranch_scc1 L_b_14
s_waitcnt vmcnt(4)
L_b_14:
s_waitcnt vmcnt(5)
buffer_load_dwordx4 v1, s[8:11], s28 offen offset:0 nt lds
s_add_u32 m0, s63, 11008
s_cmpk_gt_u32 s61, 61
s_cbranch_scc1 L_b_15
s_waitcnt vmcnt(4)
L_b_15:
s_waitcnt vmcnt(5)
buffer_load_dwordx4 v1, s[8:11], s28 offen offset:256 nt lds
s_add_u32 m0, s63, 10240
s_cmpk_gt_u32 s61, 62
s_cbranch_scc1 L_b_16
s_waitcnt vmcnt(4)
L_b_16:
s_waitcnt vmcnt(5)
buffer_load_dwordx4 v1, s[8:11], s28 offen offset:2048 nt lds
s_add_u32 m0, s63, 11008
s_cmpk_gt_u32 s61, 63
s_cbranch_scc1 L_b_17
s_waitcnt vmcnt(4)
L_b_17:
s_waitcnt vmcnt(5)
buffer_load_dwordx4 v1, s[8:11], s28 offen offset:2304 nt lds
s_add_u32 s28, s28, 0x80000
s_bitset0_b32 s28, 24
s_add_u32 m0, s63, 14336
s_cmpk_gt_u32 s61, 64
s_cbranch_scc1 L_b_18
s_waitcnt vmcnt(4)
L_b_18:
s_waitcnt vmcnt(5)
buffer_load_dwordx4 v1, s[8:11], s28 offen offset:0 nt lds
v_mov_b32 v6, 64
s_mov_b64 exec, 1
ds_max_u32 v7, v6 offset:12
s_mov_b64 exec, -1
s_add_u32 m0, s63, 15104
s_cmpk_gt_u32 s61, 65
s_cbranch_scc1 L_b_19
s_waitcnt vmcnt(4)
L_b_19:
s_waitcnt vmcnt(5)
buffer_load_dwordx4 v1, s[8:11], s28 offen offset:256 nt lds
s_add_u32 m0, s63, 14336
s_cmpk_gt_u32 s61, 66
s_cbranch_scc1 L_b_20
s_waitcnt vmcnt(4)
L_b_20:
s_waitcnt vmcnt(5)
buffer_load_dwordx4 v1, s[8:11], s28 offen offset:2048 nt lds
s_add_u32 m0, s63, 15104
s_cmpk_gt_u32 s61, 67
s_cbranch_scc1 L_b_21
s_waitcnt vmcnt(4)
L_b_21:
s_waitcnt vmcnt(5)
buffer_load_dwordx4 v1, s[8:11], s28 offen offset:2304 nt lds
s_add_u32 s28, s28, 0x80000
s_bitset0_b32 s28, 24
s_add_u32 m0, s63, 18432
s_cmpk_gt_u32 s61, 68
s_cbranch_scc1 L_b_22
s_waitcnt vmcnt(4)
L_b_22:
s_waitcnt vmcnt(5)
buffer_load_dwordx4 v1, s[8:11], s28 offen offset:0 nt lds
s_add_u32 m0, s63, 19200
s_cmpk_gt_u32 s61, 69
s_cbranch_scc1 L_b_23
s_waitcnt vmcnt(4)
L_b_23:
s_waitcnt vmcnt(5)
buffer_load_dwordx4 v1, s[8:11], s28 offen offset:256 nt lds
s_add_u32 m0, s63, 18432
s_cmpk_gt_u32 s61, 70
s_cbranch_scc1 L_b_24
s_waitcnt vmcnt(4)
L_b_24:
s_waitcnt vmcnt(5)
buffer_load_dwordx4 v1, s[8:11], s28 offen offset:2048 nt lds
s_add_u32 m0, s63, 19200
s_cmpk_gt_u32 s61, 71
s_cbranch_scc1 L_b_25
s_waitcnt vmcnt(4)
L_b_25:
s_waitcnt vmcnt(5)
buffer_load_dwordx4 v1, s[8:11], s28 offen offset:2304 nt lds
s_add_u32 s28, s28, 0x80000
s_bitset0_b32 s28, 24
s_add_u32 m0, s63, 22528
s_cmpk_gt_u32 s61, 72
s_cbranch_scc1 L_b_26
s_waitcnt vmcnt(4)
L_b_26:
s_waitcnt vmcnt(5)
buffer_load_dwordx4 v1, s[8:11], s28 offen offset:0 nt lds
s_add_u32 m0, s63, 23296
s_cmpk_gt_u32 s61, 73
s_cbranch_scc1 L_b_27
s_waitcnt vmcnt(4)
L_b_27:
s_waitcnt vmcnt(5)
buffer_load_dwordx4 v1, s[8:11], s28 offen offset:256 nt lds
s_add_u32 m0, s63, 22528
s_cmpk_gt_u32 s61, 74
s_cbranch_scc1 L_b_28
s_waitcnt vmcnt(4)
L_b_28:
s_waitcnt vmcnt(5)
buffer_load_dwordx4 v1, s[8:11], s28 offen offset:2048 nt lds
s_add_u32 m0, s63, 23296
s_cmpk_gt_u32 s61, 75
s_cbranch_scc1 L_b_29
s_waitcnt vmcnt(4)
L_b_29:
s_waitcnt vmcnt(5)
buffer_load_dwordx4 v1, s[8:11], s28 offen offset:2304 nt lds
s_add_u32 s28, s28, 0x80000
s_bitset0_b32 s28, 24
s_add_u32 m0, s63, 26624
s_cmpk_gt_u32 s61, 76
s_cbranch_scc1 L_b_30
s_waitcnt vmcnt(4)
L_b_30:
s_waitcnt vmcnt(5)
buffer_load_dwordx4 v1, s[8:11], s28 offen offset:0 nt lds
s_add_u32 m0, s63, 27392
s_cmpk_gt_u32 s61, 77
s_cbranch_scc1 L_b_31
s_waitcnt vmcnt(4)
L_b_31:
s_waitcnt vmcnt(5)
buffer_load_dwordx4 v1, s[8:11], s28 offen offset:256 nt lds
s_add_u32 m0, s63, 26624
s_cmpk_gt_u32 s61, 78
s_cbranch_scc1 L_b_32
s_waitcnt vmcnt(4)
L_b_32:
s_waitcnt vmcnt(5)
buffer_load_dwordx4 v1, s[8:11], s28 offen offset:2048 nt lds
s_add_u32 m0, s63, 27392
s_cmpk_gt_u32 s61, 79
s_cbranch_scc1 L_b_33
s_waitcnt vmcnt(4)
L_b_33:
s_waitcnt vmcnt(5)
buffer_load_dwordx4 v1, s[8:11], s28 offen offset:2304 nt lds
s_add_u32 s28, s28, 0x80000
s_bitset0_b32 s28, 24
s_add_u32 m0, s63, 30720
s_cmpk_gt_u32 s61, 80
s_cbranch_scc1 L_b_34
s_waitcnt vmcnt(4)
L_b_34:
s_waitcnt vmcnt(5)
buffer_load_dwordx4 v1, s[8:11], s28 offen offset:0 nt lds
s_add_u32 m0, s63, 31488
s_cmpk_gt_u32 s61, 81
s_cbranch_scc1 L_b_35
s_waitcnt vmcnt(4)
L_b_35:
s_waitcnt vmcnt(5)
buffer_load_dwordx4 v1, s[8:11], s28 offen offset:256 nt lds
s_mov_b32 s30, 262144
L_w_36:
ds_read_b32 v5, v7 offset:0
ds_read_b128 v[28:31], v12 offset:256
ds_read_b128 v[32:35], v12 offset:512
s_waitcnt lgkmcnt(0)
v_readfirstlane_b32 s7, v5
s_cmp_ge_u32 s7, 1
s_cbranch_scc1 L_w_36_d
s_sleep 1
s_sub_u32 s30, s30, 1
s_cmp_lg_u32 s30, 0
s_cbranch_scc1 L_w_36
L_w_36_d:
v_bfe_u32 v5, v0, 3, 1
v_cmp_eq_u32 vcc, 0, v5
s_nop 1
v_cndmask_b32 v20, 0, v28, vcc
v_cndmask_b32 v21, 0, v29, vcc
v_cndmask_b32 v22, 0, v30, vcc
v_cndmask_b32 v23, 0, v31, vcc
v_cndmask_b32 v24, 0, v32, vcc
v_cndmask_b32 v25, 0, v33, vcc
v_cndmask_b32 v26, 0, v34, vcc
v_cndmask_b32 v27, 0, v35, vcc
v_cmp_eq_u32 vcc, 1, v5
s_nop 1
v_cndmask_b32 v28, 0, v28, vcc
v_cndmask_b32 v29, 0, v29, vcc
v_cndmask_b32 v30, 0, v30, vcc
v_cndmask_b32 v31, 0, v31, vcc
v_cndmask_b32 v32, 0, v32, vcc
v_cndmask_b32 v33, 0, v33, vcc
v_cndmask_b32 v34, 0, v34, vcc
v_cndmask_b32 v35, 0, v35, vcc
v_mfma_f32_16x16x32_bf16 v[12:15], v[20:23], v[36:39], 0
v_mfma_f32_16x16x32_bf16 v[12:15], v[24:27], v[40:43], v[12:15]
v_mfma_f32_16x16x32_bf16 v[12:15], v[28:31], v[44:47], v[12:15]
v_mfma_f32_16x16x32_bf16 v[12:15], v[32:35], v[48:51], v[12:15]
s_cmpk_gt_u32 s61, 82
s_cbranch_scc1 L_b_37
s_waitcnt vmcnt(4)
L_b_37:
s_waitcnt vmcnt(5)
buffer_load_dwordx4 v[36:39], v1, s[8:11], s28 offen offset:2048 nt
v_mfma_f32_16x16x32_bf16 v[16:19], v[20:23], v[52:55], 0
v_mfma_f32_16x16x32_bf16 v[16:19], v[24:27], v[56:59], v[16:19]
v_mfma_f32_16x16x32_bf16 v[16:19], v[28:31], v[60:63], v[16:19]
s_nop 0
v_mov_b32_dpp v5, v12 quad_perm:[0,0,0,0] row_mask:0xf bank_mask:0xf
s_nop 1
v_add_f32_dpp v5, v13, v5 quad_perm:[1,1,1,1] row_mask:0xf bank_mask:0xf
s_nop 1
v_add_f32_dpp v5, v14, v5 quad_perm:[2,2,2,2] row_mask:0xf bank_mask:0xf
s_nop 1
v_add_f32_dpp v5, v15, v5 quad_perm:[3,3,3,3] row_mask:0xf bank_mask:0xf
ds_write_b32 v3, v5 offset:0
v_mfma_f32_16x16x32_bf16 v[16:19], v[32:35], v[64:67], v[16:19]
s_cmpk_gt_u32 s61, 83
s_cbranch_scc1 L_b_38
s_waitcnt vmcnt(4)
L_b_38:
s_waitcnt vmcnt(5)
buffer_load_dwordx4 v[40:43], v1, s[8:11], s28 offen offset:2304 nt
s_add_u32 s28, s28, 0x80000
s_bitset0_b32 s28, 24
v_mfma_f32_16x16x32_bf16 v[12:15], v[20:23], v[68:71], 0
v_mfma_f32_16x16x32_bf16 v[12:15], v[24:27], v[72:75], v[12:15]
v_mfma_f32_16x16x32_bf16 v[12:15], v[28:31], v[76:79], v[12:15]
v_mov_b32_dpp v5, v16 quad_perm:[0,0,0,0] row_mask:0xf bank_mask:0xf
s_nop 1
v_add_f32_dpp v5, v17, v5 quad_perm:[1,1,1,1] row_mask:0xf bank_mask:0xf
s_nop 1
v_add_f32_dpp v5, v18, v5 quad_perm:[2,2,2,2] row_mask:0xf bank_mask:0xf
s_nop 1
v_add_f32_dpp v5, v19, v5 quad_perm:[3,3,3,3] row_mask:0xf bank_mask:0xf
ds_write_b32 v3, v5 offset:64
v_mfma_f32_16x16x32_bf16 v[12:15], v[32:35], v[80:83], v[12:15]
s_cmpk_gt_u32 s61, 84
s_cbranch_scc1 L_b_39
s_waitcnt vmcnt(4)
L_b_39:
s_waitcnt vmcnt(5)
buffer_load_dwordx4 v[44:47], v1, s[8:11], s28 offen offset:0 nt
v_mfma_f32_16x16x32_bf16 v[16:19], v[20:23], v[84:87], 0
v_mfma_f32_16x16x32_bf16 v[16:19], v[24:27], v[88:91], v[16:19]
v_mfma_f32_16x16x32_bf16 v[16:19], v[28:31], v[92:95], v[16:19]
s_nop 0
v_mov_b32_dpp v5, v12 quad_perm:[0,0,0,0] row_mask:0xf bank_mask:0xf
s_nop 1
v_add_f32_dpp v5, v13, v5 quad_perm:[1,1,1,1] row_mask:0xf bank_mask:0xf
s_nop 1
v_add_f32_dpp v5, v14, v5 quad_perm:[2,2,2,2] row_mask:0xf bank_mask:0xf
s_nop 1
v_add_f32_dpp v5, v15, v5 quad_perm:[3,3,3,3] row_mask:0xf bank_mask:0xf
ds_write_b32 v3, v5 offset:128
v_mfma_f32_16x16x32_bf16 v[16:19], v[32:35], v[96:99], v[16:19]
s_cmpk_gt_u32 s61, 85
s_cbranch_scc1 L_b_40
s_waitcnt vmcnt(4)
L_b_40:
s_waitcnt vmcnt(5)
buffer_load_dwordx4 v[48:51], v1, s[8:11], s28 offen offset:256 nt
v_mfma_f32_16x16x32_bf16 v[12:15], v[20:23], v[100:103], 0
v_mfma_f32_16x16x32_bf16 v[12:15], v[24:27], v[104:107], v[12:15]
v_mfma_f32_16x16x32_bf16 v[12:15], v[28:31], v[108:111], v[12:15]
s_nop 0
v_mov_b32_dpp v5, v16 quad_perm:[0,0,0,0] row_mask:0xf bank_mask:0xf
s_nop 1
v_add_f32_dpp v5, v17, v5 quad_perm:[1,1,1,1] row_mask:0xf bank_mask:0xf
s_nop 1
v_add_f32_dpp v5, v18, v5 quad_perm:[2,2,2,2] row_mask:0xf bank_mask:0xf
s_nop 1
v_add_f32_dpp v5, v19, v5 quad_perm:[3,3,3,3] row_mask:0xf bank_mask:0xf
ds_write_b32 v3, v5 offset:192
v_mfma_f32_16x16x32_bf16 v[12:15], v[32:35], v[112:115], v[12:15]
s_cmpk_gt_u32 s61, 86
s_cbranch_scc1 L_b_41
s_waitcnt vmcnt(4)
L_b_41:
s_waitcnt vmcnt(5)
buffer_load_dwordx4 v[52:55], v1, s[8:11], s28 offen offset:2048 nt
v_mfma_f32_16x16x32_bf16 v[16:19], v[20:23], v[116:119], 0
v_mfma_f32_16x16x32_bf16 v[16:19], v[24:27], v[120:123], v[16:19]
v_mfma_f32_16x16x32_bf16 v[16:19], v[28:31], v[124:127], v[16:19]
s_nop 0
v_mov_b32_dpp v5, v12 quad_perm:[0,0,0,0] row_mask:0xf bank_mask:0xf
s_nop 1
v_add_f32_dpp v5, v13, v5 quad_perm:[1,1,1,1] row_mask:0xf bank_mask:0xf
s_nop 1
v_add_f32_dpp v5, v14, v5 quad_perm:[2,2,2,2] row_mask:0xf bank_mask:0xf
s_nop 1
v_add_f32_dpp v5, v15, v5 quad_perm:[3,3,3,3] row_mask:0xf bank_mask:0xf
ds_write_b32 v3, v5 offset:256
v_mfma_f32_16x16x32_bf16 v[16:19], v[32:35], v[128:131], v[16:19]
s_cmpk_gt_u32 s61, 87
s_cbranch_scc1 L_b_42
s_waitcnt vmcnt(4)
L_b_42:
s_waitcnt vmcnt(5)
buffer_load_dwordx4 v[56:59], v1, s[8:11], s28 offen offset:2304 nt
s_add_u32 s28, s28, 0x80000
s_bitset0_b32 s28, 24
v_mfma_f32_16x16x32_bf16 v[12:15], v[20:23], v[132:135], 0
v_mfma_f32_16x16x32_bf16 v[12:15], v[24:27], v[136:139], v[12:15]
v_mfma_f32_16x16x32_bf16 v[12:15], v[28:31], v[140:143], v[12:15]
v_mov_b32_dpp v5, v16 quad_perm:[0,0,0,0] row_mask:0xf bank_mask:0xf
s_nop 1
v_add_f32_dpp v5, v17, v5 quad_perm:[1,1,1,1] row_mask:0xf bank_mask:0xf
s_nop 1
v_add_f32_dpp v5, v18, v5 quad_perm:[2,2,2,2] row_mask:0xf bank_mask:0xf
s_nop 1
v_add_f32_dpp v5, v19, v5 quad_perm:[3,3,3,3] row_mask:0xf bank_mask:0xf
ds_write_b32 v3, v5 offset:320
v_mfma_f32_16x16x32_bf16 v[12:15], v[32:35], v[144:147], v[12:15]
s_waitcnt vmcnt(4)
buffer_load_dwordx4 v[60:63], v1, s[8:11], s28 offen offset:0 nt
s_cmp_lg_u32 s64, 0
s_cbranch_scc1 L_c_43
v_mov_b32 v6, 1
s_mov_b64 exec, 1
ds_add_rtn_u32 v253, v7, v6 offset:64
s_mov_b64 exec, -1
L_c_43:
v_mfma_f32_16x16x32_bf16 v[16:19], v[20:23], v[148:151], 0
v_mfma_f32_16x16x32_bf16 v[16:19], v[24:27], v[152:155], v[16:19]
v_mfma_f32_16x16x32_bf16 v[16:19], v[28:31], v[156:159], v[16:19]
s_nop 0
v_mov_b32_dpp v5, v12 quad_perm:[0,0,0,0] row_mask:0xf bank_mask:0xf
s_nop 1
v_add_f32_dpp v5, v13, v5 quad_perm:[1,1,1,1] row_mask:0xf bank_mask:0xf
s_nop 1
v_add_f32_dpp v5, v14, v5 quad_perm:[2,2,2,2] row_mask:0xf bank_mask:0xf
s_nop 1
v_add_f32_dpp v5, v15, v5 quad_perm:[3,3,3,3] row_mask:0xf bank_mask:0xf
ds_write_b32 v3, v5 offset:384
v_mfma_f32_16x16x32_bf16 v[16:19], v[32:35], v[160:163], v[16:19]
s_waitcnt vmcnt(4)
buffer_load_dwordx4 v[64:67], v1, s[8:11], s28 offen offset:256 nt
v_mfma_f32_16x16x32_bf16 v[12:15], v[20:23], v[164:167], 0
v_mfma_f32_16x16x32_bf16 v[12:15], v[24:27], v[168:171], v[12:15]
v_mfma_f32_16x16x32_bf16 v[12:15], v[28:31], v[172:175], v[12:15]
s_nop 2
v_mov_b32_dpp v5, v16 quad_perm:[0,0,0,0] row_mask:0xf bank_mask:0xf
s_nop 1
v_add_f32_dpp v5, v17, v5 quad_perm:[1,1,1,1] row_mask:0xf bank_mask:0xf
s_nop 1
v_add_f32_dpp v5, v18, v5 quad_perm:[2,2,2,2] row_mask:0xf bank_mask:0xf
s_nop 1
v_add_f32_dpp v5, v19, v5 quad_perm:[3,3,3,3] row_mask:0xf bank_mask:0xf
ds_write_b32 v3, v5 offset:448
v_mfma_f32_16x16x32_bf16 v[12:15], v[32:35], v[176:179], v[12:15]
s_waitcnt vmcnt(4)
buffer_load_dwordx4 v[68:71], v1, s[8:11], s28 offen offset:2048 nt
v_mfma_f32_16x16x32_bf16 v[16:19], v[20:23], v[180:183], 0
v_mfma_f32_16x16x32_bf16 v[16:19], v[24:27], v[184:187], v[16:19]
v_mfma_f32_16x16x32_bf16 v[16:19], v[28:31], v[188:191], v[16:19]
s_nop 2
v_mov_b32_dpp v5, v12 quad_perm:[0,0,0,0] row_mask:0xf bank_mask:0xf
s_nop 1
v_add_f32_dpp v5, v13, v5 quad_perm:[1,1,1,1] row_mask:0xf bank_mask:0xf
s_nop 1
v_add_f32_dpp v5, v14, v5 quad_perm:[2,2,2,2] row_mask:0xf bank_mask:0xf
s_nop 1
v_add_f32_dpp v5, v15, v5 quad_perm:[3,3,3,3] row_mask:0xf bank_mask:0xf
ds_write_b32 v3, v5 offset:512
v_mfma_f32_16x16x32_bf16 v[16:19], v[32:35], v[192:195], v[16:19]
s_waitcnt vmcnt(4)
buffer_load_dwordx4 v[72:75], v1, s[8:11], s28 offen offset:2304 nt
s_add_u32 s28, s28, 0x80000
s_bitset0_b32 s28, 24
v_mfma_f32_16x16x32_bf16 v[12:15], v[20:23], v[196:199], 0
v_mfma_f32_16x16x32_bf16 v[12:15], v[24:27], v[200:203], v[12:15]
v_mfma_f32_16x16x32_bf16 v[12:15], v[28:31], v[204:207], v[12:15]
s_nop 0
v_mov_b32_dpp v5, v16 quad_perm:[0,0,0,0] row_mask:0xf bank_mask:0xf
s_nop 1
v_add_f32_dpp v5, v17, v5 quad_perm:[1,1,1,1] row_mask:0xf bank_mask:0xf
s_nop 1
v_add_f32_dpp v5, v18, v5 quad_perm:[2,2,2,2] row_mask:0xf bank_mask:0xf
s_nop 1
v_add_f32_dpp v5, v19, v5 quad_perm:[3,3,3,3] row_mask:0xf bank_mask:0xf
ds_write_b32 v3, v5 offset:576
v_mfma_f32_16x16x32_bf16 v[12:15], v[32:35], v[208:211], v[12:15]
s_waitcnt vmcnt(4)
buffer_load_dwordx4 v[76:79], v1, s[8:11], s28 offen offset:0 nt
s_cmp_lg_u32 s64, 1
s_cbranch_scc1 L_c_44
v_mov_b32 v6, 1
s_mov_b64 exec, 1
ds_add_rtn_u32 v253, v7, v6 offset:64
s_mov_b64 exec, -1
L_c_44:
v_mfma_f32_16x16x32_bf16 v[16:19], v[20:23], v[212:215], 0
v_mfma_f32_16x16x32_bf16 v[16:19], v[24:27], v[216:219], v[16:19]
v_mfma_f32_16x16x32_bf16 v[16:19], v[28:31], v[220:223], v[16:19]
s_nop 0
v_mov_b32_dpp v5, v12 quad_perm:[0,0,0,0] row_mask:0xf bank_mask:0xf
s_nop 1
v_add_f32_dpp v5, v13, v5 quad_perm:[1,1,1,1] row_mask:0xf bank_mask:0xf
s_nop 1
v_add_f32_dpp v5, v14, v5 quad_perm:[2,2,2,2] row_mask:0xf bank_mask:0xf
s_nop 1
v_add_f32_dpp v5, v15, v5 quad_perm:[3,3,3,3] row_mask:0xf bank_mask:0xf
ds_write_b32 v3, v5 offset:640
v_mfma_f32_16x16x32_bf16 v[16:19], v[32:35], v[224:227], v[16:19]
s_waitcnt vmcnt(4)
buffer_load_dwordx4 v[80:83], v1, s[8:11], s28 offen offset:256 nt
v_mfma_f32_16x16x32_bf16 v[12:15], v[20:23], v[228:231], 0
v_mfma_f32_16x16x32_bf16 v[12:15], v[24:27], v[232:235], v[12:15]
ds_read_b128 v[84:87], v252 offset:0
v_mfma_f32_16x16x32_bf16 v[12:15], v[28:31], v[236:239], v[12:15]
s_nop 1
v_mov_b32_dpp v5, v16 quad_perm:[0,0,0,0] row_mask:0xf bank_mask:0xf
s_nop 1
v_add_f32_dpp v5, v17, v5 quad_perm:[1,1,1,1] row_mask:0xf bank_mask:0xf
s_nop 1
v_add_f32_dpp v5, v18, v5 quad_perm:[2,2,2,2] row_mask:0xf bank_mask:0xf
s_nop 1
v_add_f32_dpp v5, v19, v5 quad_perm:[3,3,3,3] row_mask:0xf bank_mask:0xf
ds_write_b32 v3, v5 offset:704
ds_read_b128 v[88:91], v252 offset:1024
v_mfma_f32_16x16x32_bf16 v[12:15], v[32:35], v[240:243], v[12:15]
s_waitcnt vmcnt(4)
buffer_load_dwordx4 v[92:95], v1, s[8:11], s28 offen offset:2048 nt
s_cmp_lg_u32 s64, 0
s_cbranch_scc1 L_c_45
ds_read_b32 v254, v7 offset:128
L_c_45:
ds_read_b128 v[96:99], v252 offset:2048
v_mfma_f32_16x16x32_bf16 v[16:19], v[20:23], v[244:247], 0
ds_read_b128 v[100:103], v252 offset:3072
v_mfma_f32_16x16x32_bf16 v[16:19], v[24:27], v[248:251], v[16:19]
ds_read_b128 v[104:107], v252 offset:4096
s_waitcnt lgkmcnt(5)
v_mfma_f32_16x16x32_bf16 v[16:19], v[28:31], v[84:87], v[16:19]
v_mov_b32_dpp v5, v12 quad_perm:[0,0,0,0] row_mask:0xf bank_mask:0xf
s_nop 1
v_add_f32_dpp v5, v13, v5 quad_perm:[1,1,1,1] row_mask:0xf bank_mask:0xf
s_nop 1
v_add_f32_dpp v5, v14, v5 quad_perm:[2,2,2,2] row_mask:0xf bank_mask:0xf
s_nop 1
v_add_f32_dpp v5, v15, v5 quad_perm:[3,3,3,3] row_mask:0xf bank_mask:0xf
ds_write_b32 v3, v5 offset:768
ds_read_b128 v[108:111], v252 offset:5120
s_waitcnt lgkmcnt(5)
v_mfma_f32_16x16x32_bf16 v[16:19], v[32:35], v[88:91], v[16:19]
s_waitcnt vmcnt(4)
buffer_load_dwordx4 v[112:115], v1, s[8:11], s28 offen offset:2304 nt
s_add_u32 s28, s28, 0x80000
s_bitset0_b32 s28, 24
s_cmp_lg_u32 s64, 0
s_cbranch_scc1 L_c_46
s_waitcnt lgkmcnt(0)
v_readfirstlane_b32 s7, v253
v_readfirstlane_b32 s65, v254
s_mul_i32 s7, s7, 3
s_sub_u32 s7, s7, 4
s_add_u32 s7, s7, s65
s_add_u32 s61, s7, 96
s_sub_u32 s60, 96, s7
L_c_46:
ds_read_b128 v[116:119], v252 offset:6144
s_waitcnt lgkmcnt(5)
v_mfma_f32_16x16x32_bf16 v[12:15], v[20:23], v[96:99], 0
ds_read_b128 v[120:123], v252 offset:7168
s_waitcnt lgkmcnt(5)
v_mfma_f32_16x16x32_bf16 v[12:15], v[24:27], v[100:103], v[12:15]
ds_read_b128 v[124:127], v252 offset:8192
s_waitcnt lgkmcnt(5)
v_mfma_f32_16x16x32_bf16 v[12:15], v[28:31], v[104:107], v[12:15]
v_mov_b32_dpp v5, v16 quad_perm:[0,0,0,0] row_mask:0xf bank_mask:0xf
s_nop 1
v_add_f32_dpp v5, v17, v5 quad_perm:[1,1,1,1] row_mask:0xf bank_mask:0xf
s_nop 1
v_add_f32_dpp v5, v18, v5 quad_perm:[2,2,2,2] row_mask:0xf bank_mask:0xf
s_nop 1
v_add_f32_dpp v5, v19, v5 quad_perm:[3,3,3,3] row_mask:0xf bank_mask:0xf
ds_write_b32 v3, v5 offset:832
ds_read_b128 v[128:131], v252 offset:9216
s_waitcnt lgkmcnt(5)
v_mfma_f32_16x16x32_bf16 v[12:15], v[32:35], v[108:111], v[12:15]
s_cmpk_gt_u32 s61, 96
s_cbranch_scc1 L_b_47
s_cmpk_le_u32 s60, 96
s_cbranch_scc1 L_b_47_n
s_waitcnt vmcnt(3)
L_b_47_n:
s_waitcnt vmcnt(4)
L_b_47:
buffer_load_dwordx4 v[132:135], v1, s[8:11], s28 offen offset:0 nt
ds_read_b128 v[136:139], v252 offset:10240
s_waitcnt lgkmcnt(5)
v_mfma_f32_16x16x32_bf16 v[16:19], v[20:23], v[116:119], 0
ds_read_b128 v[140:143], v252 offset:11264
s_waitcnt lgkmcnt(5)
v_mfma_f32_16x16x32_bf16 v[16:19], v[24:27], v[120:123], v[16:19]
ds_read_b128 v[144:147], v252 offset:12288
s_waitcnt lgkmcnt(5)
v_mfma_f32_16x16x32_bf16 v[16:19], v[28:31], v[124:127], v[16:19]
v_mov_b32_dpp v5, v12 quad_perm:[0,0,0,0] row_mask:0xf bank_mask:0xf
s_nop 1
v_add_f32_dpp v5, v13, v5 quad_perm:[1,1,1,1] row_mask:0xf bank_mask:0xf
s_nop 1
v_add_f32_dpp v5, v14, v5 quad_perm:[2,2,2,2] row_mask:0xf bank_mask:0xf
s_nop 1
v_add_f32_dpp v5, v15, v5 quad_perm:[3,3,3,3] row_mask:0xf bank_mask:0xf
ds_write_b32 v3, v5 offset:896
ds_read_b128 v[148:151], v252 offset:13312
s_waitcnt lgkmcnt(5)
v_mfma_f32_16x16x32_bf16 v[16:19], v[32:35], v[128:131], v[16:19]
s_cmpk_gt_u32 s61, 97
s_cbranch_scc1 L_b_48
s_cmpk_le_u32 s60, 97
s_cbranch_scc1 L_b_48_n
s_waitcnt vmcnt(3)
L_b_48_n:
s_waitcnt vmcnt(4)
L_b_48:
s_waitcnt vmcnt(5)
buffer_load_dwordx4 v[152:155], v1, s[8:11], s28 offen offset:256 nt
ds_read_b128 v[156:159], v252 offset:14336
s_waitcnt lgkmcnt(5)
v_mfma_f32_16x16x32_bf16 v[12:15], v[20:23], v[136:139], 0
ds_read_b128 v[160:163], v252 offset:15360
s_waitcnt lgkmcnt(5)
v_mfma_f32_16x16x32_bf16 v[12:15], v[24:27], v[140:143], v[12:15]
ds_read_b128 v[164:167], v252 offset:16384
s_waitcnt lgkmcnt(5)
v_mfma_f32_16x16x32_bf16 v[12:15], v[28:31], v[144:147], v[12:15]
v_mov_b32_dpp v5, v16 quad_perm:[0,0,0,0] row_mask:0xf bank_mask:0xf
s_nop 1
v_add_f32_dpp v5, v17, v5 quad_perm:[1,1,1,1] row_mask:0xf bank_mask:0xf
s_nop 1
v_add_f32_dpp v5, v18, v5 quad_perm:[2,2,2,2] row_mask:0xf bank_mask:0xf
s_nop 1
v_add_f32_dpp v5, v19, v5 quad_perm:[3,3,3,3] row_mask:0xf bank_mask:0xf
ds_write_b32 v3, v5 offset:960
ds_read_b128 v[168:171], v252 offset:17408
s_waitcnt lgkmcnt(5)
v_mfma_f32_16x16x32_bf16 v[12:15], v[32:35], v[148:151], v[12:15]
s_cmpk_gt_u32 s61, 98
s_cbranch_scc1 L_b_49
s_cmpk_le_u32 s60, 98
s_cbranch_scc1 L_b_49_n
s_waitcnt vmcnt(3)
L_b_49_n:
s_waitcnt vmcnt(4)
L_b_49:
s_waitcnt vmcnt(5)
buffer_load_dwordx4 v[172:175], v1, s[8:11], s28 offen offset:2048 nt
s_cmp_lg_u32 s64, 0
s_cbranch_scc1 L_c_50
ds_read_b32 v254, v7 offset:128
L_c_50:
s_cmp_lg_u32 s64, 1
s_cbranch_scc1 L_c_51
ds_read_b32 v254, v7 offset:128
L_c_51:
ds_read_b128 v[176:179], v252 offset:18432
s_waitcnt lgkmcnt(5)
v_mfma_f32_16x16x32_bf16 v[16:19], v[20:23], v[156:159], 0
ds_read_b128 v[180:183], v252 offset:19456
s_waitcnt lgkmcnt(5)
v_mfma_f32_16x16x32_bf16 v[16:19], v[24:27], v[160:163], v[16:19]
ds_read_b128 v[184:187], v252 offset:20480
s_waitcnt lgkmcnt(5)
v_mfma_f32_16x16x32_bf16 v[16:19], v[28:31], v[164:167], v[16:19]
v_mov_b32_dpp v5, v12 quad_perm:[0,0,0,0] row_mask:0xf bank_mask:0xf
s_nop 1
v_add_f32_dpp v5, v13, v5 quad_perm:[1,1,1,1] row_mask:0xf bank_mask:0xf
s_nop 1
v_add_f32_dpp v5, v14, v5 quad_perm:[2,2,2,2] row_mask:0xf bank_mask:0xf
s_nop 1
v_add_f32_dpp v5, v15, v5 quad_perm:[3,3,3,3] row_mask:0xf bank_mask:0xf
ds_write_b32 v3, v5 offset:1024
ds_read_b128 v[188:191], v252 offset:21504
s_waitcnt lgkmcnt(5)
v_mfma_f32_16x16x32_bf16 v[16:19], v[32:35], v[168:171], v[16:19]
s_cmpk_gt_u32 s61, 99
s_cbranch_scc1 L_b_52
s_cmpk_le_u32 s60, 99
s_cbranch_scc1 L_b_52_n
s_waitcnt vmcnt(3)
L_b_52_n:
s_waitcnt vmcnt(4)
L_b_52:
s_waitcnt vmcnt(5)
buffer_load_dwordx4 v[192:195], v1, s[8:11], s28 offen offset:2304 nt
s_add_u32 s28, s28, 0x80000
s_bitset0_b32 s28, 24
s_cmp_lg_u32 s64, 0
s_cbranch_scc1 L_c_53
s_waitcnt lgkmcnt(0)
v_readfirstlane_b32 s7, v253
v_readfirstlane_b32 s65, v254
s_mul_i32 s7, s7, 3
s_sub_u32 s7, s7, 4
s_add_u32 s7, s7, s65
s_add_u32 s61, s7, 96
s_sub_u32 s60, 96, s7
L_c_53:
s_cmp_lg_u32 s64, 1
s_cbranch_scc1 L_c_54
s_waitcnt lgkmcnt(0)
v_readfirstlane_b32 s7, v253
v_readfirstlane_b32 s65, v254
s_mul_i32 s7, s7, 3
s_sub_u32 s7, s7, 4
s_add_u32 s7, s7, s65
s_add_u32 s61, s7, 100
s_sub_u32 s60, 100, s7
L_c_54:
ds_read_b128 v[196:199], v252 offset:22528
s_waitcnt lgkmcnt(5)
v_mfma_f32_16x16x32_bf16 v[12:15], v[20:23], v[176:179], 0
ds_read_b128 v[200:203], v252 offset:23552
s_waitcnt lgkmcnt(5)
v_mfma_f32_16x16x32_bf16 v[12:15], v[24:27], v[180:183], v[12:15]
ds_read_b128 v[204:207], v252 offset:24576
s_waitcnt lgkmcnt(5)
v_mfma_f32_16x16x32_bf16 v[12:15], v[28:31], v[184:187], v[12:15]
v_mov_b32_dpp v5, v16 quad_perm:[0,0,0,0] row_mask:0xf bank_mask:0xf
s_nop 1
v_add_f32_dpp v5, v17, v5 quad_perm:[1,1,1,1] row_mask:0xf bank_mask:0xf
s_nop 1
v_add_f32_dpp v5, v18, v5 quad_perm:[2,2,2,2] row_mask:0xf bank_mask:0xf
s_nop 1
v_add_f32_dpp v5, v19, v5 quad_perm:[3,3,3,3] row_mask:0xf bank_mask:0xf
ds_write_b32 v3, v5 offset:1088
ds_read_b128 v[208:211], v252 offset:25600
s_waitcnt lgkmcnt(5)
v_mfma_f32_16x16x32_bf16 v[12:15], v[32:35], v[188:191], v[12:15]
s_cmpk_gt_u32 s61, 100
s_cbranch_scc1 L_b_55
s_cmpk_le_u32 s60, 100
s_cbranch_scc1 L_b_55_n
s_waitcnt vmcnt(3)
L_b_55_n:
s_waitcnt vmcnt(4)
L_b_55:
s_waitcnt vmcnt(5)
buffer_load_dwordx4 v[212:215], v1, s[8:11], s28 offen offset:0 nt
ds_read_b128 v[216:219], v252 offset:26624
s_waitcnt lgkmcnt(5)
v_mfma_f32_16x16x32_bf16 v[16:19], v[20:23], v[196:199], 0
ds_read_b128 v[220:223], v252 offset:27648
s_waitcnt lgkmcnt(5)
v_mfma_f32_16x16x32_bf16 v[16:19], v[24:27], v[200:203], v[16:19]
s_waitcnt lgkmcnt(4)
v_mfma_f32_16x16x32_bf16 v[16:19], v[28:31], v[204:207], v[16:19]
v_mov_b32_dpp v5, v12 quad_perm:[0,0,0,0] row_mask:0xf bank_mask:0xf
s_nop 1
v_add_f32_dpp v5, v13, v5 quad_perm:[1,1,1,1] row_mask:0xf bank_mask:0xf
s_nop 1
v_add_f32_dpp v5, v14, v5 quad_perm:[2,2,2,2] row_mask:0xf bank_mask:0xf
s_nop 1
v_add_f32_dpp v5, v15, v5 quad_perm:[3,3,3,3] row_mask:0xf bank_mask:0xf
ds_write_b32 v3, v5 offset:1152
s_waitcnt lgkmcnt(3)
v_mfma_f32_16x16x32_bf16 v[16:19], v[32:35], v[208:211], v[16:19]
s_cmpk_gt_u32 s61, 101
s_cbranch_scc1 L_b_56
s_cmpk_le_u32 s60, 101
s_cbranch_scc1 L_b_56_n
s_waitcnt vmcnt(3)
L_b_56_n:
s_waitcnt vmcnt(4)
L_b_56:
s_waitcnt vmcnt(5)
buffer_load_dwordx4 v[224:227], v1, s[8:11], s28 offen offset:256 nt
s_waitcnt lgkmcnt(2)
v_mfma_f32_16x16x32_bf16 v[12:15], v[20:23], v[216:219], 0
s_waitcnt lgkmcnt(1)
v_mfma_f32_16x16x32_bf16 v[12:15], v[24:27], v[220:223], v[12:15]
v_mfma_f32_16x16x32_bf16 v[12:15], v[28:31], v[36:39], v[12:15]
v_mov_b32_dpp v5, v16 quad_perm:[0,0,0,0] row_mask:0xf bank_mask:0xf
s_nop 1
v_add_f32_dpp v5, v17, v5 quad_perm:[1,1,1,1] row_mask:0xf bank_mask:0xf
s_nop 1
v_add_f32_dpp v5, v18, v5 quad_perm:[2,2,2,2] row_mask:0xf bank_mask:0xf
s_nop 1
v_add_f32_dpp v5, v19, v5 quad_perm:[3,3,3,3] row_mask:0xf bank_mask:0xf
ds_write_b32 v3, v5 offset:1216
v_mfma_f32_16x16x32_bf16 v[12:15], v[32:35], v[40:43], v[12:15]
s_cmpk_gt_u32 s61, 102
s_cbranch_scc1 L_b_57
s_cmpk_le_u32 s60, 102
s_cbranch_scc1 L_b_57_n
s_waitcnt vmcnt(3)
L_b_57_n:
s_waitcnt vmcnt(4)
L_b_57:
s_waitcnt vmcnt(5)
buffer_load_dwordx4 v[228:231], v1, s[8:11], s28 offen offset:2048 nt
s_cmp_lg_u32 s64, 1
s_cbranch_scc1 L_c_58
ds_read_b32 v254, v7 offset:128
L_c_58:
v_mfma_f32_16x16x32_bf16 v[16:19], v[20:23], v[44:47], 0
v_mfma_f32_16x16x32_bf16 v[16:19], v[24:27], v[48:51], v[16:19]
v_mfma_f32_16x16x32_bf16 v[16:19], v[28:31], v[52:55], v[16:19]
v_mov_b32_dpp v5, v12 quad_perm:[0,0,0,0] row_mask:0xf bank_mask:0xf
s_nop 1
v_add_f32_dpp v5, v13, v5 quad_perm:[1,1,1,1] row_mask:0xf bank_mask:0xf
s_nop 1
v_add_f32_dpp v5, v14, v5 quad_perm:[2,2,2,2] row_mask:0xf bank_mask:0xf
s_nop 1
v_add_f32_dpp v5, v15, v5 quad_perm:[3,3,3,3] row_mask:0xf bank_mask:0xf
ds_write_b32 v3, v5 offset:1280
v_mfma_f32_16x16x32_bf16 v[16:19], v[32:35], v[56:59], v[16:19]
s_cmpk_gt_u32 s61, 103
s_cbranch_scc1 L_b_59
s_cmpk_le_u32 s60, 103
s_cbranch_scc1 L_b_59_n
s_waitcnt vmcnt(3)
L_b_59_n:
s_waitcnt vmcnt(4)
L_b_59:
s_waitcnt vmcnt(5)
buffer_load_dwordx4 v[232:235], v1, s[8:11], s28 offen offset:2304 nt
s_add_u32 s28, s28, 0x80000
s_bitset0_b32 s28, 24
s_cmp_lg_u32 s64, 1
s_cbranch_scc1 L_c_60
s_waitcnt lgkmcnt(0)
v_readfirstlane_b32 s7, v253
v_readfirstlane_b32 s65, v254
s_mul_i32 s7, s7, 3
s_sub_u32 s7, s7, 4
s_add_u32 s7, s7, s65
s_add_u32 s61, s7, 100
s_sub_u32 s60, 100, s7
L_c_60:
v_mfma_f32_16x16x32_bf16 v[12:15], v[20:23], v[60:63], 0
v_mfma_f32_16x16x32_bf16 v[12:15], v[24:27], v[64:67], v[12:15]
v_mfma_f32_16x16x32_bf16 v[12:15], v[28:31], v[68:71], v[12:15]
v_mov_b32_dpp v5, v16 quad_perm:[0,0,0,0] row_mask:0xf bank_mask:0xf
s_nop 1
v_add_f32_dpp v5, v17, v5 quad_perm:[1,1,1,1] row_mask:0xf bank_mask:0xf
s_nop 1
v_add_f32_dpp v5, v18, v5 quad_perm:[2,2,2,2] row_mask:0xf bank_mask:0xf
s_nop 1
v_add_f32_dpp v5, v19, v5 quad_perm:[3,3,3,3] row_mask:0xf bank_mask:0xf
ds_write_b32 v3, v5 offset:1344
v_mfma_f32_16x16x32_bf16 v[12:15], v[32:35], v[72:75], v[12:15]
s_cmpk_gt_u32 s61, 104
s_cbranch_scc1 L_b_61
s_cmpk_le_u32 s60, 104
s_cbranch_scc1 L_b_61_n
s_waitcnt vmcnt(3)
L_b_61_n:
s_waitcnt vmcnt(4)
L_b_61:
s_waitcnt vmcnt(5)
buffer_load_dwordx4 v[236:239], v1, s[8:11], s28 offen offset:0 nt
v_mfma_f32_16x16x32_bf16 v[16:19], v[20:23], v[76:79], 0
v_mfma_f32_16x16x32_bf16 v[16:19], v[24:27], v[80:83], v[16:19]
v_mfma_f32_16x16x32_bf16 v[16:19], v[28:31], v[92:95], v[16:19]
s_nop 0
v_mov_b32_dpp v5, v12 quad_perm:[0,0,0,0] row_mask:0xf bank_mask:0xf
s_nop 1
v_add_f32_dpp v5, v13, v5 quad_perm:[1,1,1,1] row_mask:0xf bank_mask:0xf
s_nop 1
v_add_f32_dpp v5, v14, v5 quad_perm:[2,2,2,2] row_mask:0xf bank_mask:0xf
s_nop 1
v_add_f32_dpp v5, v15, v5 quad_perm:[3,3,3,3] row_mask:0xf bank_mask:0xf
ds_write_b32 v3, v5 offset:1408
v_mfma_f32_16x16x32_bf16 v[16:19], v[32:35], v[112:115], v[16:19]
s_cmpk_gt_u32 s61, 105
s_cbranch_scc1 L_b_62
s_cmpk_le_u32 s60, 105
s_cbranch_scc1 L_b_62_n
s_waitcnt vmcnt(3)
L_b_62_n:
s_waitcnt vmcnt(4)
L_b_62:
s_waitcnt vmcnt(5)
buffer_load_dwordx4 v[240:243], v1, s[8:11], s28 offen offset:256 nt
v_mfma_f32_16x16x32_bf16 v[12:15], v[20:23], v[132:135], 0
v_mfma_f32_16x16x32_bf16 v[12:15], v[24:27], v[152:155], v[12:15]
v_mfma_f32_16x16x32_bf16 v[12:15], v[28:31], v[172:175], v[12:15]
s_nop 0
v_mov_b32_dpp v5, v16 quad_perm:[0,0,0,0] row_mask:0xf bank_mask:0xf
s_nop 1
v_add_f32_dpp v5, v17, v5 quad_perm:[1,1,1,1] row_mask:0xf bank_mask:0xf
s_nop 1
v_add_f32_dpp v5, v18, v5 quad_perm:[2,2,2,2] row_mask:0xf bank_mask:0xf
s_nop 1
v_add_f32_dpp v5, v19, v5 quad_perm:[3,3,3,3] row_mask:0xf bank_mask:0xf
ds_write_b32 v3, v5 offset:1472
v_mfma_f32_16x16x32_bf16 v[12:15], v[32:35], v[192:195], v[12:15]
s_cmpk_gt_u32 s61, 106
s_cbranch_scc1 L_b_63
s_cmpk_le_u32 s60, 106
s_cbranch_scc1 L_b_63_n
s_waitcnt vmcnt(3)
L_b_63_n:
s_waitcnt vmcnt(4)
L_b_63:
s_waitcnt vmcnt(5)
buffer_load_dwordx4 v[244:247], v1, s[8:11], s28 offen offset:2048 nt
v_mfma_f32_16x16x32_bf16 v[16:19], v[20:23], v[212:215], 0
s_cmpk_gt_u32 s61, 107
s_cbranch_scc1 L_b_64
s_cmpk_le_u32 s60, 107
s_cbranch_scc1 L_b_64_n
s_waitcnt vmcnt(3)
L_b_64_n:
s_waitcnt vmcnt(4)
L_b_64:
s_waitcnt vmcnt(5)
buffer_load_dwordx4 v[248:251], v1, s[8:11], s28 offen offset:2304 nt
s_add_u32 s28, s28, 0x80000
s_bitset0_b32 s28, 24
v_mfma_f32_16x16x32_bf16 v[16:19], v[24:27], v[224:227], v[16:19]
s_cmpk_gt_u32 s61, 108
s_cbranch_scc1 L_b_65
s_cmpk_le_u32 s60, 108
s_cbranch_scc1 L_b_65_n
s_waitcnt vmcnt(3)
L_b_65_n:
s_waitcnt vmcnt(4)
L_b_65:
s_waitcnt vmcnt(5)
buffer_load_dwordx4 v[84:87], v1, s[8:11], s28 offen offset:0 nt
v_mfma_f32_16x16x32_bf16 v[16:19], v[28:31], v[228:231], v[16:19]
v_mov_b32_dpp v5, v12 quad_perm:[0,0,0,0] row_mask:0xf bank_mask:0xf
s_nop 1
v_add_f32_dpp v5, v13, v5 quad_perm:[1,1,1,1] row_mask:0xf bank_mask:0xf
s_nop 1
v_add_f32_dpp v5, v14, v5 quad_perm:[2,2,2,2] row_mask:0xf bank_mask:0xf
s_nop 1
v_add_f32_dpp v5, v15, v5 quad_perm:[3,3,3,3] row_mask:0xf bank_mask:0xf
ds_write_b32 v3, v5 offset:1536
s_cmpk_gt_u32 s61, 109
s_cbranch_scc1 L_b_66
s_cmpk_le_u32 s60, 109
s_cbranch_scc1 L_b_66_n
s_waitcnt vmcnt(3)
L_b_66_n:
s_waitcnt vmcnt(4)
L_b_66:
s_waitcnt vmcnt(5)
buffer_load_dwordx4 v[88:91], v1, s[8:11], s28 offen offset:256 nt
v_mfma_f32_16x16x32_bf16 v[16:19], v[32:35], v[232:235], v[16:19]
s_cmpk_gt_u32 s61, 110
s_cbranch_scc1 L_b_67
s_cmpk_le_u32 s60, 110
s_cbranch_scc1 L_b_67_n
s_waitcnt vmcnt(3)
L_b_67_n:
s_waitcnt vmcnt(4)
L_b_67:
s_waitcnt vmcnt(5)
buffer_load_dwordx4 v[96:99], v1, s[8:11], s28 offen offset:2048 nt
v_mfma_f32_16x16x32_bf16 v[12:15], v[20:23], v[236:239], 0
s_cmpk_gt_u32 s61, 111
s_cbranch_scc1 L_b_68
s_cmpk_le_u32 s60, 111
s_cbranch_scc1 L_b_68_n
s_waitcnt vmcnt(3)
L_b_68_n:
s_waitcnt vmcnt(4)
L_b_68:
s_waitcnt vmcnt(5)
buffer_load_dwordx4 v[100:103], v1, s[8:11], s28 offen offset:2304 nt
s_add_u32 s28, s28, 0x80000
s_bitset0_b32 s28, 24
v_mfma_f32_16x16x32_bf16 v[12:15], v[24:27], v[240:243], v[12:15]
s_cmpk_gt_u32 s61, 112
s_cbranch_scc1 L_b_69
s_cmpk_le_u32 s60, 112
s_cbranch_scc1 L_b_69_n
s_waitcnt vmcnt(3)
L_b_69_n:
s_waitcnt vmcnt(4)
L_b_69:
s_waitcnt vmcnt(5)
buffer_load_dwordx4 v[104:107], v1, s[8:11], s28 offen offset:0 nt
v_mfma_f32_16x16x32_bf16 v[12:15], v[28:31], v[244:247], v[12:15]
v_mov_b32_dpp v5, v16 quad_perm:[0,0,0,0] row_mask:0xf bank_mask:0xf
s_nop 1
v_add_f32_dpp v5, v17, v5 quad_perm:[1,1,1,1] row_mask:0xf bank_mask:0xf
s_nop 1
v_add_f32_dpp v5, v18, v5 quad_perm:[2,2,2,2] row_mask:0xf bank_mask:0xf
s_nop 1
v_add_f32_dpp v5, v19, v5 quad_perm:[3,3,3,3] row_mask:0xf bank_mask:0xf
ds_write_b32 v3, v5 offset:1600
s_cmpk_gt_u32 s61, 113
s_cbranch_scc1 L_b_70
s_cmpk_le_u32 s60, 113
s_cbranch_scc1 L_b_70_n
s_waitcnt vmcnt(3)
L_b_70_n:
s_waitcnt vmcnt(4)
L_b_70:
s_waitcnt vmcnt(5)
buffer_load_dwordx4 v[108:111], v1, s[8:11], s28 offen offset:256 nt
v_mfma_f32_16x16x32_bf16 v[12:15], v[32:35], v[248:251], v[12:15]
s_cmpk_gt_u32 s61, 114
s_cbranch_scc1 L_b_71
s_cmpk_le_u32 s60, 114
s_cbranch_scc1 L_b_71_n
s_waitcnt vmcnt(3)
L_b_71_n:
s_waitcnt vmcnt(4)
L_b_71:
s_waitcnt vmcnt(5)
buffer_load_dwordx4 v[116:119], v1, s[8:11], s28 offen offset:2048 nt
v_mfma_f32_16x16x32_bf16 v[16:19], v[20:23], v[84:87], 0
s_cmpk_gt_u32 s61, 115
s_cbranch_scc1 L_b_72
s_cmpk_le_u32 s60, 115
s_cbranch_scc1 L_b_72_n
s_waitcnt vmcnt(3)
L_b_72_n:
s_waitcnt vmcnt(4)
L_b_72:
s_waitcnt vmcnt(5)
buffer_load_dwordx4 v[120:123], v1, s[8:11], s28 offen offset:2304 nt
s_add_u32 s28, s28, 0x80000
s_bitset0_b32 s28, 24
v_mfma_f32_16x16x32_bf16 v[16:19], v[24:27], v[88:91], v[16:19]
s_cmpk_gt_u32 s61, 116
s_cbranch_scc1 L_b_73
s_cmpk_le_u32 s60, 116
s_cbranch_scc1 L_b_73_n
s_waitcnt vmcnt(3)
L_b_73_n:
s_waitcnt vmcnt(4)
L_b_73:
s_waitcnt vmcnt(5)
buffer_load_dwordx4 v[124:127], v1, s[8:11], s28 offen offset:0 nt
v_mfma_f32_16x16x32_bf16 v[16:19], v[28:31], v[96:99], v[16:19]
v_mov_b32_dpp v5, v12 quad_perm:[0,0,0,0] row_mask:0xf bank_mask:0xf
s_nop 1
v_add_f32_dpp v5, v13, v5 quad_perm:[1,1,1,1] row_mask:0xf bank_mask:0xf
s_nop 1
v_add_f32_dpp v5, v14, v5 quad_perm:[2,2,2,2] row_mask:0xf bank_mask:0xf
s_nop 1
v_add_f32_dpp v5, v15, v5 quad_perm:[3,3,3,3] row_mask:0xf bank_mask:0xf
ds_write_b32 v3, v5 offset:1664
s_cmpk_gt_u32 s61, 117
s_cbranch_scc1 L_b_74
s_cmpk_le_u32 s60, 117
s_cbranch_scc1 L_b_74_n
s_waitcnt vmcnt(3)
L_b_74_n:
s_waitcnt vmcnt(4)
L_b_74:
s_waitcnt vmcnt(5)
buffer_load_dwordx4 v[128:131], v1, s[8:11], s28 offen offset:256 nt
v_mfma_f32_16x16x32_bf16 v[16:19], v[32:35], v[100:103], v[16:19]
s_cmpk_gt_u32 s61, 118
s_cbranch_scc1 L_b_75
s_cmpk_le_u32 s60, 118
s_cbranch_scc1 L_b_75_n
s_waitcnt vmcnt(3)
L_b_75_n:
s_waitcnt vmcnt(4)
L_b_75:
s_waitcnt vmcnt(5)
buffer_load_dwordx4 v[136:139], v1, s[8:11], s28 offen offset:2048 nt
v_mfma_f32_16x16x32_bf16 v[12:15], v[20:23], v[104:107], 0
s_cmpk_gt_u32 s61, 119
s_cbranch_scc1 L_b_76
s_cmpk_le_u32 s60, 119
s_cbranch_scc1 L_b_76_n
s_waitcnt vmcnt(3)
L_b_76_n:
s_waitcnt vmcnt(4)
L_b_76:
s_waitcnt vmcnt(5)
buffer_load_dwordx4 v[140:143], v1, s[8:11], s28 offen offset:2304 nt
s_add_u32 s28, s28, 0x80000
s_bitset0_b32 s28, 24
v_mfma_f32_16x16x32_bf16 v[12:15], v[24:27], v[108:111], v[12:15]
s_cmpk_gt_u32 s61, 120
s_cbranch_scc1 L_b_77
s_cmpk_le_u32 s60, 120
s_cbranch_scc1 L_b_77_n
s_waitcnt vmcnt(3)
L_b_77_n:
s_waitcnt vmcnt(4)
L_b_77:
s_waitcnt vmcnt(5)
buffer_load_dwordx4 v[144:147], v1, s[8:11], s28 offen offset:0 nt
v_mfma_f32_16x16x32_bf16 v[12:15], v[28:31], v[116:119], v[12:15]
v_mov_b32_dpp v5, v16 quad_perm:[0,0,0,0] row_mask:0xf bank_mask:0xf
s_nop 1
v_add_f32_dpp v5, v17, v5 quad_perm:[1,1,1,1] row_mask:0xf bank_mask:0xf
s_nop 1
v_add_f32_dpp v5, v18, v5 quad_perm:[2,2,2,2] row_mask:0xf bank_mask:0xf
s_nop 1
v_add_f32_dpp v5, v19, v5 quad_perm:[3,3,3,3] row_mask:0xf bank_mask:0xf
ds_write_b32 v3, v5 offset:1728
s_cmpk_gt_u32 s61, 121
s_cbranch_scc1 L_b_78
s_cmpk_le_u32 s60, 121
s_cbranch_scc1 L_b_78_n
s_waitcnt vmcnt(3)
L_b_78_n:
s_waitcnt vmcnt(4)
L_b_78:
s_waitcnt vmcnt(5)
buffer_load_dwordx4 v[148:151], v1, s[8:11], s28 offen offset:256 nt
v_mfma_f32_16x16x32_bf16 v[12:15], v[32:35], v[120:123], v[12:15]
s_cmpk_gt_u32 s61, 122
s_cbranch_scc1 L_b_79
s_cmpk_le_u32 s60, 122
s_cbranch_scc1 L_b_79_n
s_waitcnt vmcnt(3)
L_b_79_n:
s_waitcnt vmcnt(4)
L_b_79:
s_waitcnt vmcnt(5)
buffer_load_dwordx4 v[156:159], v1, s[8:11], s28 offen offset:2048 nt
v_mfma_f32_16x16x32_bf16 v[16:19], v[20:23], v[124:127], 0
s_cmpk_gt_u32 s61, 123
s_cbranch_scc1 L_b_80
s_cmpk_le_u32 s60, 123
s_cbranch_scc1 L_b_80_n
s_waitcnt vmcnt(3)
L_b_80_n:
s_waitcnt vmcnt(4)
L_b_80:
s_waitcnt vmcnt(5)
buffer_load_dwordx4 v[160:163], v1, s[8:11], s28 offen offset:2304 nt
s_add_u32 s28, s28, 0x80000
s_bitset0_b32 s28, 24
v_mfma_f32_16x16x32_bf16 v[16:19], v[24:27], v[128:131], v[16:19]
s_cmpk_gt_u32 s61, 124
s_cbranch_scc1 L_b_81
s_cmpk_le_u32 s60, 124
s_cbranch_scc1 L_b_81_n
s_waitcnt vmcnt(3)
L_b_81_n:
s_waitcnt vmcnt(4)
L_b_81:
s_waitcnt vmcnt(5)
buffer_load_dwordx4 v[164:167], v1, s[8:11], s28 offen offset:0 nt
v_mfma_f32_16x16x32_bf16 v[16:19], v[28:31], v[136:139], v[16:19]
v_mov_b32_dpp v5, v12 quad_perm:[0,0,0,0] row_mask:0xf bank_mask:0xf
s_nop 1
v_add_f32_dpp v5, v13, v5 quad_perm:[1,1,1,1] row_mask:0xf bank_mask:0xf
s_nop 1
v_add_f32_dpp v5, v14, v5 quad_perm:[2,2,2,2] row_mask:0xf bank_mask:0xf
s_nop 1
v_add_f32_dpp v5, v15, v5 quad_perm:[3,3,3,3] row_mask:0xf bank_mask:0xf
ds_write_b32 v3, v5 offset:1792
s_cmpk_gt_u32 s61, 125
s_cbranch_scc1 L_b_82
s_cmpk_le_u32 s60, 125
s_cbranch_scc1 L_b_82_n
s_waitcnt vmcnt(3)
L_b_82_n:
s_waitcnt vmcnt(4)
L_b_82:
s_waitcnt vmcnt(5)
buffer_load_dwordx4 v[168:171], v1, s[8:11], s28 offen offset:256 nt
v_mfma_f32_16x16x32_bf16 v[16:19], v[32:35], v[140:143], v[16:19]
s_cmpk_gt_u32 s61, 126
s_cbranch_scc1 L_b_83
s_cmpk_le_u32 s60, 126
s_cbranch_scc1 L_b_83_n
s_waitcnt vmcnt(3)
L_b_83_n:
s_waitcnt vmcnt(4)
L_b_83:
s_waitcnt vmcnt(5)
buffer_load_dwordx4 v[176:179], v1, s[8:11], s28 offen offset:2048 nt
v_mfma_f32_16x16x32_bf16 v[12:15], v[20:23], v[144:147], 0
s_cmpk_gt_u32 s61, 127
s_cbranch_scc1 L_b_84
s_cmpk_le_u32 s60, 127
s_cbranch_scc1 L_b_84_n
s_waitcnt vmcnt(3)
L_b_84_n:
s_waitcnt vmcnt(4)
L_b_84:
s_waitcnt vmcnt(5)
buffer_load_dwordx4 v[180:183], v1, s[8:11], s28 offen offset:2304 nt
v_mfma_f32_16x16x32_bf16 v[12:15], v[24:27], v[148:151], v[12:15]
s_cmpk_gt_u32 s61, 128
s_cbranch_scc1 L_b_85
s_cmpk_le_u32 s60, 128
s_cbranch_scc1 L_b_85_n
s_waitcnt vmcnt(3)
L_b_85_n:
s_waitcnt vmcnt(4)
L_b_85:
s_waitcnt vmcnt(5)
buffer_load_dwordx4 v[184:187], v2, s[12:15], s29 offen offset:0 nt
s_cmp_lg_u32 s64, 0
s_cbranch_scc1 L_c_86
v_mov_b32 v6, 1
s_mov_b64 exec, 1
ds_add_rtn_u32 v253, v7, v6 offset:68
s_mov_b64 exec, -1
L_c_86:
v_mfma_f32_16x16x32_bf16 v[12:15], v[28:31], v[156:159], v[12:15]
v_mov_b32_dpp v5, v16 quad_perm:[0,0,0,0] row_mask:0xf bank_mask:0xf
s_nop 1
v_add_f32_dpp v5, v17, v5 quad_perm:[1,1,1,1] row_mask:0xf bank_mask:0xf
s_nop 1
v_add_f32_dpp v5, v18, v5 quad_perm:[2,2,2,2] row_mask:0xf bank_mask:0xf
s_nop 1
v_add_f32_dpp v5, v19, v5 quad_perm:[3,3,3,3] row_mask:0xf bank_mask:0xf
ds_write_b32 v3, v5 offset:1856
s_cmpk_gt_u32 s61, 129
s_cbranch_scc1 L_b_87
s_cmpk_le_u32 s60, 129
s_cbranch_scc1 L_b_87_n
s_waitcnt vmcnt(3)
L_b_87_n:
s_waitcnt vmcnt(4)
L_b_87:
s_waitcnt vmcnt(5)
buffer_load_dwordx4 v[188:191], v2, s[12:15], s29 offen offset:2048 nt
s_add_u32 s29, s29, 0x1000
v_mfma_f32_16x16x32_bf16 v[12:15], v[32:35], v[160:163], v[12:15]
s_cmpk_gt_u32 s61, 130
s_cbranch_scc1 L_b_88
s_cmpk_le_u32 s60, 130
s_cbranch_scc1 L_b_88_n
s_waitcnt vmcnt(3)
L_b_88_n:
s_waitcnt vmcnt(4)
L_b_88:
s_waitcnt vmcnt(5)
buffer_load_dwordx4 v[196:199], v2, s[12:15], s29 offen offset:0 nt
v_mfma_f32_16x16x32_bf16 v[16:19], v[20:23], v[164:167], 0
s_cmpk_gt_u32 s61, 131
s_cbranch_scc1 L_b_89
s_cmpk_le_u32 s60, 131
s_cbranch_scc1 L_b_89_n
s_waitcnt vmcnt(3)
L_b_89_n:
s_waitcnt vmcnt(4)
L_b_89:
s_waitcnt vmcnt(5)
buffer_load_dwordx4 v[200:203], v2, s[12:15], s29 offen offset:2048 nt
s_add_u32 s29, s29, 0x7f000
s_bitset0_b32 s29, 24
v_mfma_f32_16x16x32_bf16 v[16:19], v[24:27], v[168:171], v[16:19]
s_cmpk_gt_u32 s61, 132
s_cbranch_scc1 L_b_90
s_cmpk_le_u32 s60, 132
s_cbranch_scc1 L_b_90_n
s_waitcnt vmcnt(3)
L_b_90_n:
s_waitcnt vmcnt(4)
L_b_90:
s_waitcnt vmcnt(5)
buffer_load_dwordx4 v[204:207], v2, s[12:15], s29 offen offset:0 nt
s_cmp_lg_u32 s64, 1
s_cbranch_scc1 L_c_91
v_mov_b32 v6, 1
s_mov_b64 exec, 1
ds_add_rtn_u32 v253, v7, v6 offset:68
s_mov_b64 exec, -1
L_c_91:
v_mfma_f32_16x16x32_bf16 v[16:19], v[28:31], v[176:179], v[16:19]
v_mov_b32_dpp v5, v12 quad_perm:[0,0,0,0] row_mask:0xf bank_mask:0xf
s_nop 1
v_add_f32_dpp v5, v13, v5 quad_perm:[1,1,1,1] row_mask:0xf bank_mask:0xf
s_nop 1
v_add_f32_dpp v5, v14, v5 quad_perm:[2,2,2,2] row_mask:0xf bank_mask:0xf
s_nop 1
v_add_f32_dpp v5, v15, v5 quad_perm:[3,3,3,3] row_mask:0xf bank_mask:0xf
ds_write_b32 v3, v5 offset:1920
s_cmpk_gt_u32 s61, 133
s_cbranch_scc1 L_b_92
s_cmpk_le_u32 s60, 133
s_cbranch_scc1 L_b_92_n
s_waitcnt vmcnt(3)
L_b_92_n:
s_waitcnt vmcnt(4)
L_b_92:
s_waitcnt vmcnt(5)
buffer_load_dwordx4 v[208:211], v2, s[12:15], s29 offen offset:2048 nt
s_add_u32 s29, s29, 0x1000
v_mfma_f32_16x16x32_bf16 v[16:19], v[32:35], v[180:183], v[16:19]
s_nop 7
v_mov_b32_dpp v5, v16 quad_perm:[0,0,0,0] row_mask:0xf bank_mask:0xf
s_nop 1
v_add_f32_dpp v5, v17, v5 quad_perm:[1,1,1,1] row_mask:0xf bank_mask:0xf
s_nop 1
v_add_f32_dpp v5, v18, v5 quad_perm:[2,2,2,2] row_mask:0xf bank_mask:0xf
s_nop 1
v_add_f32_dpp v5, v19, v5 quad_perm:[3,3,3,3] row_mask:0xf bank_mask:0xf
ds_write_b32 v3, v5 offset:1984
v_mov_b32 v6, 1
s_mov_b64 exec, 1
ds_add_u32 v7, v6 offset:4
s_mov_b64 exec, -1
s_cmpk_gt_u32 s61, 134
s_cbranch_scc1 L_b_93
s_cmpk_le_u32 s60, 134
s_cbranch_scc1 L_b_93_n
s_waitcnt vmcnt(3)
L_b_93_n:
s_waitcnt vmcnt(4)
L_b_93:
s_waitcnt vmcnt(5)
buffer_load_dwordx4 v[216:219], v2, s[12:15], s29 offen offset:0 nt
s_cmp_lg_u32 s64, 0
s_cbranch_scc1 L_c_94
ds_read_b32 v254, v7 offset:132
L_c_94:
s_cmpk_gt_u32 s61, 135
s_cbranch_scc1 L_b_95
s_cmpk_le_u32 s60, 135
s_cbranch_scc1 L_b_95_n
s_waitcnt vmcnt(3)
L_b_95_n:
s_waitcnt vmcnt(4)
L_b_95:
s_waitcnt vmcnt(5)
buffer_load_dwordx4 v[220:223], v2, s[12:15], s29 offen offset:2048 nt
s_add_u32 s29, s29, 0x7f000
s_bitset0_b32 s29, 24
s_cmp_lg_u32 s64, 0
s_cbranch_scc1 L_c_96
s_waitcnt lgkmcnt(0)
v_readfirstlane_b32 s7, v253
v_readfirstlane_b32 s65, v254
s_mul_i32 s7, s7, 3
s_sub_u32 s7, s7, 4
s_add_u32 s7, s7, s65
s_add_u32 s61, s7, 136
s_sub_u32 s60, 136, s7
L_c_96:
s_cmpk_gt_u32 s61, 136
s_cbranch_scc1 L_b_97
s_cmpk_le_u32 s60, 136
s_cbranch_scc1 L_b_97_n
s_waitcnt vmcnt(3)
L_b_97_n:
s_waitcnt vmcnt(4)
L_b_97:
s_waitcnt vmcnt(5)
buffer_load_dwordx4 v[36:39], v2, s[12:15], s29 offen offset:0 nt
s_cmpk_gt_u32 s61, 137
s_cbranch_scc1 L_b_98
s_cmpk_le_u32 s60, 137
s_cbranch_scc1 L_b_98_n
s_waitcnt vmcnt(3)
L_b_98_n:
s_waitcnt vmcnt(4)
L_b_98:
s_waitcnt vmcnt(5)
buffer_load_dwordx4 v[40:43], v2, s[12:15], s29 offen offset:2048 nt
s_add_u32 s29, s29, 0x1000
s_cmpk_gt_u32 s61, 138
s_cbranch_scc1 L_b_99
s_cmpk_le_u32 s60, 138
s_cbranch_scc1 L_b_99_n
s_waitcnt vmcnt(3)
L_b_99_n:
s_waitcnt vmcnt(4)
L_b_99:
s_waitcnt vmcnt(5)
buffer_load_dwordx4 v[44:47], v2, s[12:15], s29 offen offset:0 nt
s_cmp_lg_u32 s64, 0
s_cbranch_scc1 L_c_100
ds_read_b32 v254, v7 offset:132
L_c_100:
s_cmp_lg_u32 s64, 1
s_cbranch_scc1 L_c_101
ds_read_b32 v254, v7 offset:132
L_c_101:
s_cmpk_gt_u32 s61, 139
s_cbranch_scc1 L_b_102
s_cmpk_le_u32 s60, 139
s_cbranch_scc1 L_b_102_n
s_waitcnt vmcnt(3)
L_b_102_n:
s_waitcnt vmcnt(4)
L_b_102:
s_waitcnt vmcnt(5)
buffer_load_dwordx4 v[48:51], v2, s[12:15], s29 offen offset:2048 nt
s_add_u32 s29, s29, 0x7f000
s_bitset0_b32 s29, 24
s_cmp_lg_u32 s64, 0
s_cbranch_scc1 L_c_103
s_waitcnt lgkmcnt(0)
v_readfirstlane_b32 s7, v253
v_readfirstlane_b32 s65, v254
s_mul_i32 s7, s7, 3
s_sub_u32 s7, s7, 4
s_add_u32 s7, s7, s65
s_add_u32 s61, s7, 136
s_sub_u32 s60, 136, s7
L_c_103:
s_cmp_lg_u32 s64, 1
s_cbranch_scc1 L_c_104
s_waitcnt lgkmcnt(0)
v_readfirstlane_b32 s7, v253
v_readfirstlane_b32 s65, v254
s_mul_i32 s7, s7, 3
s_sub_u32 s7, s7, 4
s_add_u32 s7, s7, s65
s_add_u32 s61, s7, 140
s_sub_u32 s60, 140, s7
L_c_104:
s_cmpk_gt_u32 s61, 140
s_cbranch_scc1 L_b_105
s_cmpk_le_u32 s60, 140
s_cbranch_scc1 L_b_105_n
s_waitcnt vmcnt(3)
L_b_105_n:
s_waitcnt vmcnt(4)
L_b_105:
s_waitcnt vmcnt(5)
buffer_load_dwordx4 v[52:55], v2, s[12:15], s29 offen offset:0 nt
s_cmpk_gt_u32 s61, 141
s_cbranch_scc1 L_b_106
s_cmpk_le_u32 s60, 141
s_cbranch_scc1 L_b_106_n
s_waitcnt vmcnt(3)
L_b_106_n:
s_waitcnt vmcnt(4)
L_b_106:
s_waitcnt vmcnt(5)
buffer_load_dwordx4 v[56:59], v2, s[12:15], s29 offen offset:2048 nt
s_add_u32 s29, s29, 0x1000
s_cmpk_gt_u32 s61, 142
s_cbranch_scc1 L_b_107
s_cmpk_le_u32 s60, 142
s_cbranch_scc1 L_b_107_n
s_waitcnt vmcnt(3)
L_b_107_n:
s_waitcnt vmcnt(4)
L_b_107:
s_waitcnt vmcnt(5)
buffer_load_dwordx4 v[60:63], v2, s[12:15], s29 offen offset:0 nt
s_cmp_lg_u32 s64, 1
s_cbranch_scc1 L_c_108
ds_read_b32 v254, v7 offset:132
L_c_108:
s_cmpk_gt_u32 s61, 143
s_cbranch_scc1 L_b_109
s_cmpk_le_u32 s60, 143
s_cbranch_scc1 L_b_109_n
s_waitcnt vmcnt(3)
L_b_109_n:
s_waitcnt vmcnt(4)
L_b_109:
s_waitcnt vmcnt(5)
buffer_load_dwordx4 v[64:67], v2, s[12:15], s29 offen offset:2048 nt
s_add_u32 s29, s29, 0x7f000
s_bitset0_b32 s29, 24
s_cmp_lg_u32 s64, 1
s_cbranch_scc1 L_c_110
s_waitcnt lgkmcnt(0)
v_readfirstlane_b32 s7, v253
v_readfirstlane_b32 s65, v254
s_mul_i32 s7, s7, 3
s_sub_u32 s7, s7, 4
s_add_u32 s7, s7, s65
s_add_u32 s61, s7, 140
s_sub_u32 s60, 140, s7
L_c_110:
s_cmpk_gt_u32 s61, 144
s_cbranch_scc1 L_b_111
s_cmpk_le_u32 s60, 144
s_cbranch_scc1 L_b_111_n
s_waitcnt vmcnt(3)
L_b_111_n:
s_waitcnt vmcnt(4)
L_b_111:
s_waitcnt vmcnt(5)
buffer_load_dwordx4 v[68:71], v2, s[12:15], s29 offen offset:0 nt
s_cmpk_gt_u32 s61, 145
s_cbranch_scc1 L_b_112
s_cmpk_le_u32 s60, 145
s_cbranch_scc1 L_b_112_n
s_waitcnt vmcnt(3)
L_b_112_n:
s_waitcnt vmcnt(4)
L_b_112:
s_waitcnt vmcnt(5)
buffer_load_dwordx4 v[72:75], v2, s[12:15], s29 offen offset:2048 nt
s_add_u32 s29, s29, 0x1000
s_cmpk_gt_u32 s61, 146
s_cbranch_scc1 L_b_113
s_cmpk_le_u32 s60, 146
s_cbranch_scc1 L_b_113_n
s_waitcnt vmcnt(3)
L_b_113_n:
s_waitcnt vmcnt(4)
L_b_113:
s_waitcnt vmcnt(5)
buffer_load_dwordx4 v[76:79], v2, s[12:15], s29 offen offset:0 nt
s_cmpk_gt_u32 s61, 147
s_cbranch_scc1 L_b_114
s_cmpk_le_u32 s60, 147
s_cbranch_scc1 L_b_114_n
s_waitcnt vmcnt(3)
L_b_114_n:
s_waitcnt vmcnt(4)
L_b_114:
s_waitcnt vmcnt(5)
buffer_load_dwordx4 v[80:83], v2, s[12:15], s29 offen offset:2048 nt
s_add_u32 s29, s29, 0x7f000
s_bitset0_b32 s29, 24
s_cmpk_gt_u32 s61, 148
s_cbranch_scc1 L_b_115
s_cmpk_le_u32 s60, 148
s_cbranch_scc1 L_b_115_n
s_waitcnt vmcnt(3)
L_b_115_n:
s_waitcnt vmcnt(4)
L_b_115:
s_waitcnt vmcnt(5)
buffer_load_dwordx4 v[92:95], v2, s[12:15], s29 offen offset:0 nt
s_cmpk_gt_u32 s61, 149
s_cbranch_scc1 L_b_116
s_cmpk_le_u32 s60, 149
s_cbranch_scc1 L_b_116_n
s_waitcnt vmcnt(3)
L_b_116_n:
s_waitcnt vmcnt(4)
L_b_116:
s_waitcnt vmcnt(5)
buffer_load_dwordx4 v[112:115], v2, s[12:15], s29 offen offset:2048 nt
s_add_u32 s29, s29, 0x1000
s_cmpk_gt_u32 s61, 150
s_cbranch_scc1 L_b_117
s_cmpk_le_u32 s60, 150
s_cbranch_scc1 L_b_117_n
s_waitcnt vmcnt(3)
L_b_117_n:
s_waitcnt vmcnt(4)
L_b_117:
s_waitcnt vmcnt(5)
buffer_load_dwordx4 v[132:135], v2, s[12:15], s29 offen offset:0 nt
s_cmpk_gt_u32 s61, 151
s_cbranch_scc1 L_b_118
s_cmpk_le_u32 s60, 151
s_cbranch_scc1 L_b_118_n
s_waitcnt vmcnt(3)
L_b_118_n:
s_waitcnt vmcnt(4)
L_b_118:
s_waitcnt vmcnt(5)
buffer_load_dwordx4 v[152:155], v2, s[12:15], s29 offen offset:2048 nt
s_add_u32 s29, s29, 0x7f000
s_bitset0_b32 s29, 24
s_cmpk_gt_u32 s61, 152
s_cbranch_scc1 L_b_119
s_cmpk_le_u32 s60, 152
s_cbranch_scc1 L_b_119_n
s_waitcnt vmcnt(3)
L_b_119_n:
s_waitcnt vmcnt(4)
L_b_119:
s_waitcnt vmcnt(5)
buffer_load_dwordx4 v[172:175], v2, s[12:15], s29 offen offset:0 nt
s_cmpk_gt_u32 s61, 153
s_cbranch_scc1 L_b_120
s_cmpk_le_u32 s60, 153
s_cbranch_scc1 L_b_120_n
s_waitcnt vmcnt(3)
L_b_120_n:
s_waitcnt vmcnt(4)
L_b_120:
s_waitcnt vmcnt(5)
buffer_load_dwordx4 v[192:195], v2, s[12:15], s29 offen offset:2048 nt
s_add_u32 s29, s29, 0x1000
s_cmpk_gt_u32 s61, 154
s_cbranch_scc1 L_b_121
s_cmpk_le_u32 s60, 154
s_cbranch_scc1 L_b_121_n
s_waitcnt vmcnt(3)
L_b_121_n:
s_waitcnt vmcnt(4)
L_b_121:
s_waitcnt vmcnt(5)
buffer_load_dwordx4 v[212:215], v2, s[12:15], s29 offen offset:0 nt
s_cmpk_gt_u32 s61, 155
s_cbranch_scc1 L_b_122
s_cmpk_le_u32 s60, 155
s_cbranch_scc1 L_b_122_n
s_waitcnt vmcnt(3)
L_b_122_n:
s_waitcnt vmcnt(4)
L_b_122:
s_waitcnt vmcnt(5)
buffer_load_dwordx4 v[224:227], v2, s[12:15], s29 offen offset:2048 nt
s_add_u32 s29, s29, 0x7f000
s_bitset0_b32 s29, 24
s_cmpk_gt_u32 s61, 156
s_cbranch_scc1 L_b_123
s_cmpk_le_u32 s60, 156
s_cbranch_scc1 L_b_123_n
s_waitcnt vmcnt(3)
L_b_123_n:
s_waitcnt vmcnt(4)
L_b_123:
s_waitcnt vmcnt(5)
buffer_load_dwordx4 v[228:231], v2, s[12:15], s29 offen offset:0 nt
s_cmpk_gt_u32 s61, 157
s_cbranch_scc1 L_b_124
s_cmpk_le_u32 s60, 157
s_cbranch_scc1 L_b_124_n
s_waitcnt vmcnt(3)
L_b_124_n:
s_waitcnt vmcnt(4)
L_b_124:
s_waitcnt vmcnt(5)
buffer_load_dwordx4 v[232:235], v2, s[12:15], s29 offen offset:2048 nt
s_add_u32 s29, s29, 0x1000
s_cmpk_gt_u32 s61, 158
s_cbranch_scc1 L_b_125
s_cmpk_le_u32 s60, 158
s_cbranch_scc1 L_b_125_n
s_waitcnt vmcnt(3)
L_b_125_n:
s_waitcnt vmcnt(4)
L_b_125:
s_waitcnt vmcnt(5)
buffer_load_dwordx4 v[236:239], v2, s[12:15], s29 offen offset:0 nt
s_cmpk_gt_u32 s61, 159
s_cbranch_scc1 L_b_126
s_cmpk_le_u32 s60, 159
s_cbranch_scc1 L_b_126_n
s_waitcnt vmcnt(3)
L_b_126_n:
s_waitcnt vmcnt(4)
L_b_126:
s_waitcnt vmcnt(5)
buffer_load_dwordx4 v[240:243], v2, s[12:15], s29 offen offset:2048 nt
s_add_u32 s29, s29, 0x7f000
s_bitset0_b32 s29, 24
s_cmpk_gt_u32 s61, 160
s_cbranch_scc1 L_b_127
s_cmpk_le_u32 s60, 160
s_cbranch_scc1 L_b_127_n
s_waitcnt vmcnt(3)
L_b_127_n:
s_waitcnt vmcnt(4)
L_b_127:
s_waitcnt vmcnt(5)
buffer_load_dwordx4 v[244:247], v2, s[12:15], s29 offen offset:0 nt
s_cmpk_gt_u32 s61, 161
s_cbranch_scc1 L_b_128
s_cmpk_le_u32 s60, 161
s_cbranch_scc1 L_b_128_n
s_waitcnt vmcnt(3)
L_b_128_n:
s_waitcnt vmcnt(4)
L_b_128:
s_waitcnt vmcnt(5)
buffer_load_dwordx4 v[248:251], v2, s[12:15], s29 offen offset:2048 nt
s_add_u32 s29, s29, 0x1000
s_cmpk_gt_u32 s61, 162
s_cbranch_scc1 L_b_129
s_cmpk_le_u32 s60, 162
s_cbranch_scc1 L_b_129_n
s_waitcnt vmcnt(3)
L_b_129_n:
s_waitcnt vmcnt(4)
L_b_129:
s_waitcnt vmcnt(5)
buffer_load_dwordx4 v[84:87], v2, s[12:15], s29 offen offset:0 nt
s_cmpk_gt_u32 s61, 163
s_cbranch_scc1 L_b_130
s_cmpk_le_u32 s60, 163
s_cbranch_scc1 L_b_130_n
s_waitcnt vmcnt(3)
L_b_130_n:
s_waitcnt vmcnt(4)
L_b_130:
s_waitcnt vmcnt(5)
buffer_load_dwordx4 v[88:91], v2, s[12:15], s29 offen offset:2048 nt
s_add_u32 s29, s29, 0x7f000
s_bitset0_b32 s29, 24
s_cmpk_gt_u32 s61, 164
s_cbranch_scc1 L_b_131
s_cmpk_le_u32 s60, 164
s_cbranch_scc1 L_b_131_n
s_waitcnt vmcnt(3)
L_b_131_n:
s_waitcnt vmcnt(4)
L_b_131:
s_waitcnt vmcnt(5)
buffer_load_dwordx4 v[96:99], v2, s[12:15], s29 offen offset:0 nt
s_cmpk_gt_u32 s61, 165
s_cbranch_scc1 L_b_132
s_cmpk_le_u32 s60, 165
s_cbranch_scc1 L_b_132_n
s_waitcnt vmcnt(3)
L_b_132_n:
s_waitcnt vmcnt(4)
L_b_132:
s_waitcnt vmcnt(5)
buffer_load_dwordx4 v[100:103], v2, s[12:15], s29 offen offset:2048 nt
s_add_u32 s29, s29, 0x1000
s_cmpk_gt_u32 s61, 166
s_cbranch_scc1 L_b_133
s_cmpk_le_u32 s60, 166
s_cbranch_scc1 L_b_133_n
s_waitcnt vmcnt(3)
L_b_133_n:
s_waitcnt vmcnt(4)
L_b_133:
s_waitcnt vmcnt(5)
buffer_load_dwordx4 v[104:107], v2, s[12:15], s29 offen offset:0 nt
s_cmpk_gt_u32 s61, 167
s_cbranch_scc1 L_b_134
s_cmpk_le_u32 s60, 167
s_cbranch_scc1 L_b_134_n
s_waitcnt vmcnt(3)
L_b_134_n:
s_waitcnt vmcnt(4)
L_b_134:
s_waitcnt vmcnt(5)
buffer_load_dwordx4 v[108:111], v2, s[12:15], s29 offen offset:2048 nt
s_add_u32 s29, s29, 0x7f000
s_bitset0_b32 s29, 24
s_cmpk_gt_u32 s61, 168
s_cbranch_scc1 L_b_135
s_cmpk_le_u32 s60, 168
s_cbranch_scc1 L_b_135_n
s_waitcnt vmcnt(3)
L_b_135_n:
s_waitcnt vmcnt(4)
L_b_135:
s_waitcnt vmcnt(5)
buffer_load_dwordx4 v[116:119], v2, s[12:15], s29 offen offset:0 nt
s_cmp_lg_u32 s64, 0
s_cbranch_scc1 L_c_136
v_mov_b32 v6, 1
s_mov_b64 exec, 1
ds_add_rtn_u32 v253, v7, v6 offset:72
s_mov_b64 exec, -1
L_c_136:
s_cmpk_gt_u32 s61, 169
s_cbranch_scc1 L_b_137
s_cmpk_le_u32 s60, 169
s_cbranch_scc1 L_b_137_n
s_waitcnt vmcnt(3)
L_b_137_n:
s_waitcnt vmcnt(4)
L_b_137:
s_waitcnt vmcnt(5)
buffer_load_dwordx4 v[120:123], v2, s[12:15], s29 offen offset:2048 nt
s_add_u32 s29, s29, 0x1000
s_cmpk_gt_u32 s61, 170
s_cbranch_scc1 L_b_138
s_cmpk_le_u32 s60, 170
s_cbranch_scc1 L_b_138_n
s_waitcnt vmcnt(3)
L_b_138_n:
s_waitcnt vmcnt(4)
L_b_138:
s_waitcnt vmcnt(5)
buffer_load_dwordx4 v[124:127], v2, s[12:15], s29 offen offset:0 nt
s_cmpk_gt_u32 s61, 171
s_cbranch_scc1 L_b_139
s_cmpk_le_u32 s60, 171
s_cbranch_scc1 L_b_139_n
s_waitcnt vmcnt(3)
L_b_139_n:
s_waitcnt vmcnt(4)
L_b_139:
s_waitcnt vmcnt(5)
buffer_load_dwordx4 v[128:131], v2, s[12:15], s29 offen offset:2048 nt
s_add_u32 s29, s29, 0x7f000
s_bitset0_b32 s29, 24
s_cmpk_gt_u32 s61, 172
s_cbranch_scc1 L_b_140
s_cmpk_le_u32 s60, 172
s_cbranch_scc1 L_b_140_n
s_waitcnt vmcnt(3)
L_b_140_n:
s_waitcnt vmcnt(4)
L_b_140:
s_waitcnt vmcnt(5)
buffer_load_dwordx4 v[136:139], v2, s[12:15], s29 offen offset:0 nt
s_cmp_lg_u32 s64, 1
s_cbranch_scc1 L_c_141
v_mov_b32 v6, 1
s_mov_b64 exec, 1
ds_add_rtn_u32 v253, v7, v6 offset:72
s_mov_b64 exec, -1
L_c_141:
s_cmpk_gt_u32 s61, 173
s_cbranch_scc1 L_b_142
s_cmpk_le_u32 s60, 173
s_cbranch_scc1 L_b_142_n
s_waitcnt vmcnt(3)
L_b_142_n:
s_waitcnt vmcnt(4)
L_b_142:
s_waitcnt vmcnt(5)
buffer_load_dwordx4 v[140:143], v2, s[12:15], s29 offen offset:2048 nt
s_add_u32 s29, s29, 0x1000
s_cmpk_gt_u32 s61, 174
s_cbranch_scc1 L_b_143
s_cmpk_le_u32 s60, 174
s_cbranch_scc1 L_b_143_n
s_waitcnt vmcnt(3)
L_b_143_n:
s_waitcnt vmcnt(4)
L_b_143:
s_waitcnt vmcnt(5)
buffer_load_dwordx4 v[144:147], v2, s[12:15], s29 offen offset:0 nt
s_cmp_lg_u32 s64, 0
s_cbranch_scc1 L_c_144
ds_read_b32 v254, v7 offset:136
L_c_144:
s_cmpk_gt_u32 s61, 175
s_cbranch_scc1 L_b_145
s_cmpk_le_u32 s60, 175
s_cbranch_scc1 L_b_145_n
s_waitcnt vmcnt(3)
L_b_145_n:
s_waitcnt vmcnt(4)
L_b_145:
s_waitcnt vmcnt(5)
buffer_load_dwordx4 v[148:151], v2, s[12:15], s29 offen offset:2048 nt
s_add_u32 s29, s29, 0x7f000
s_bitset0_b32 s29, 24
s_cmp_lg_u32 s64, 0
s_cbranch_scc1 L_c_146
s_waitcnt lgkmcnt(0)
v_readfirstlane_b32 s7, v253
v_readfirstlane_b32 s65, v254
s_mul_i32 s7, s7, 3
s_sub_u32 s7, s7, 4
s_add_u32 s7, s7, s65
s_add_u32 s61, s7, 176
s_sub_u32 s60, 176, s7
L_c_146:
s_cmpk_gt_u32 s61, 176
s_cbranch_scc1 L_b_147
s_cmpk_le_u32 s60, 176
s_cbranch_scc1 L_b_147_n
s_waitcnt vmcnt(3)
L_b_147_n:
s_waitcnt vmcnt(4)
L_b_147:
s_waitcnt vmcnt(5)
buffer_load_dwordx4 v[156:159], v2, s[12:15], s29 offen offset:0 nt
s_cmpk_gt_u32 s61, 177
s_cbranch_scc1 L_b_148
s_cmpk_le_u32 s60, 177
s_cbranch_scc1 L_b_148_n
s_waitcnt vmcnt(3)
L_b_148_n:
s_waitcnt vmcnt(4)
L_b_148:
s_waitcnt vmcnt(5)
buffer_load_dwordx4 v[160:163], v2, s[12:15], s29 offen offset:2048 nt
s_add_u32 s29, s29, 0x1000
s_cmpk_gt_u32 s61, 178
s_cbranch_scc1 L_b_149
s_cmpk_le_u32 s60, 178
s_cbranch_scc1 L_b_149_n
s_waitcnt vmcnt(3)
L_b_149_n:
s_waitcnt vmcnt(4)
L_b_149:
s_waitcnt vmcnt(5)
buffer_load_dwordx4 v[164:167], v2, s[12:15], s29 offen offset:0 nt
s_cmp_lg_u32 s64, 0
s_cbranch_scc1 L_c_150
ds_read_b32 v254, v7 offset:136
L_c_150:
s_cmp_lg_u32 s64, 1
s_cbranch_scc1 L_c_151
ds_read_b32 v254, v7 offset:136
L_c_151:
s_cmpk_gt_u32 s61, 179
s_cbranch_scc1 L_b_152
s_cmpk_le_u32 s60, 179
s_cbranch_scc1 L_b_152_n
s_waitcnt vmcnt(3)
L_b_152_n:
s_waitcnt vmcnt(4)
L_b_152:
s_waitcnt vmcnt(5)
buffer_load_dwordx4 v[168:171], v2, s[12:15], s29 offen offset:2048 nt
s_add_u32 s29, s29, 0x7f000
s_bitset0_b32 s29, 24
s_cmp_lg_u32 s64, 0
s_cbranch_scc1 L_c_153
s_waitcnt lgkmcnt(0)
v_readfirstlane_b32 s7, v253
v_readfirstlane_b32 s65, v254
s_mul_i32 s7, s7, 3
s_sub_u32 s7, s7, 4
s_add_u32 s7, s7, s65
s_add_u32 s61, s7, 176
s_sub_u32 s60, 176, s7
L_c_153:
s_cmp_lg_u32 s64, 1
s_cbranch_scc1 L_c_154
s_waitcnt lgkmcnt(0)
v_readfirstlane_b32 s7, v253
v_readfirstlane_b32 s65, v254
s_mul_i32 s7, s7, 3
s_sub_u32 s7, s7, 4
s_add_u32 s7, s7, s65
s_add_u32 s61, s7, 180
s_sub_u32 s60, 180, s7
L_c_154:
s_cmpk_gt_u32 s61, 180
s_cbranch_scc1 L_b_155
s_cmpk_le_u32 s60, 180
s_cbranch_scc1 L_b_155_n
s_waitcnt vmcnt(3)
L_b_155_n:
s_waitcnt vmcnt(4)
L_b_155:
s_waitcnt vmcnt(5)
buffer_load_dwordx4 v[176:179], v2, s[12:15], s29 offen offset:0 nt
s_cmpk_gt_u32 s61, 181
s_cbranch_scc1 L_b_156
s_cmpk_le_u32 s60, 181
s_cbranch_scc1 L_b_156_n
s_waitcnt vmcnt(3)
L_b_156_n:
s_waitcnt vmcnt(4)
L_b_156:
s_waitcnt vmcnt(5)
buffer_load_dwordx4 v[180:183], v2, s[12:15], s29 offen offset:2048 nt
s_add_u32 s29, s29, 0x1000
s_mov_b32 s30, 262144
L_w_157:
ds_read_b32 v5, v7 offset:8
ds_read_b128 v[28:31], v4
s_waitcnt lgkmcnt(0)
v_readfirstlane_b32 s7, v5
s_cmp_ge_u32 s7, 1
s_cbranch_scc1 L_w_157_d
s_sleep 1
s_sub_u32 s30, s30, 1
s_cmp_lg_u32 s30, 0
s_cbranch_scc1 L_w_157
L_w_157_d:
s_mov_b32 s62, s7
s_waitcnt lgkmcnt(0)
ds_read_b128 v[32:35], v4 offset:64
v_and_b32 v20, v28, v8
v_and_b32 v21, v28, v9
v_and_b32 v22, v28, v10
v_and_b32 v23, v28, v11
s_nop 1
v_mfma_f32_16x16x32_bf16 v[12:15], v[20:23], v[184:187], 0
v_and_b32 v24, v29, v8
v_and_b32 v25, v29, v9
v_and_b32 v26, v29, v10
v_and_b32 v27, v29, v11
s_nop 1
v_mfma_f32_16x16x32_bf16 v[12:15], v[24:27], v[188:191], v[12:15]
v_and_b32 v20, v30, v8
v_and_b32 v21, v30, v9
v_and_b32 v22, v30, v10
v_and_b32 v23, v30, v11
s_nop 1
v_mfma_f32_16x16x32_bf16 v[12:15], v[20:23], v[196:199], v[12:15]
v_and_b32 v24, v31, v8
v_and_b32 v25, v31, v9
v_and_b32 v26, v31, v10
v_and_b32 v27, v31, v11
s_nop 1
v_mfma_f32_16x16x32_bf16 v[12:15], v[24:27], v[200:203], v[12:15]
s_cmpk_gt_u32 s61, 182
s_cbranch_scc1 L_b_158
s_cmpk_le_u32 s60, 182
s_cbranch_scc1 L_b_158_n
s_waitcnt vmcnt(3)
L_b_158_n:
s_waitcnt vmcnt(4)
L_b_158:
s_waitcnt vmcnt(5)
buffer_load_dwordx4 v[184:187], v2, s[12:15], s29 offen offset:0 nt
s_cmp_lg_u32 s64, 1
s_cbranch_scc1 L_c_159
ds_read_b32 v254, v7 offset:136
L_c_159:
s_waitcnt lgkmcnt(0)
ds_read_b128 v[28:31], v4 offset:128
v_and_b32 v20, v32, v8
v_and_b32 v21, v32, v9
v_and_b32 v22, v32, v10
v_and_b32 v23, v32, v11
s_nop 1
v_mfma_f32_16x16x32_bf16 v[12:15], v[20:23], v[204:207], v[12:15]
v_and_b32 v24, v33, v8
v_and_b32 v25, v33, v9
v_and_b32 v26, v33, v10
v_and_b32 v27, v33, v11
s_nop 1
v_mfma_f32_16x16x32_bf16 v[12:15], v[24:27], v[208:211], v[12:15]
v_and_b32 v20, v34, v8
v_and_b32 v21, v34, v9
v_and_b32 v22, v34, v10
v_and_b32 v23, v34, v11
s_nop 1
v_mfma_f32_16x16x32_bf16 v[12:15], v[20:23], v[216:219], v[12:15]
v_and_b32 v24, v35, v8
v_and_b32 v25, v35, v9
v_and_b32 v26, v35, v10
v_and_b32 v27, v35, v11
s_nop 1
v_mfma_f32_16x16x32_bf16 v[12:15], v[24:27], v[220:223], v[12:15]
s_cmpk_gt_u32 s61, 183
s_cbranch_scc1 L_b_160
s_cmpk_le_u32 s60, 183
s_cbranch_scc1 L_b_160_n
s_waitcnt vmcnt(3)
L_b_160_n:
s_waitcnt vmcnt(4)
L_b_160:
s_waitcnt vmcnt(5)
buffer_load_dwordx4 v[188:191], v2, s[12:15], s29 offen offset:2048 nt
s_add_u32 s29, s29, 0x7f000
s_bitset0_b32 s29, 24
s_cmp_lg_u32 s64, 1
s_cbranch_scc1 L_c_161
s_waitcnt lgkmcnt(0)
v_readfirstlane_b32 s7, v253
v_readfirstlane_b32 s65, v254
s_mul_i32 s7, s7, 3
s_sub_u32 s7, s7, 4
s_add_u32 s7, s7, s65
s_add_u32 s61, s7, 180
s_sub_u32 s60, 180, s7
L_c_161:
s_waitcnt lgkmcnt(0)
ds_read_b128 v[32:35], v4 offset:192
v_and_b32 v20, v28, v8
v_and_b32 v21, v28, v9
v_and_b32 v22, v28, v10
v_and_b32 v23, v28, v11
s_nop 1
v_mfma_f32_16x16x32_bf16 v[12:15], v[20:23], v[36:39], v[12:15]
v_and_b32 v24, v29, v8
v_and_b32 v25, v29, v9
v_and_b32 v26, v29, v10
v_and_b32 v27, v29, v11
s_nop 1
v_mfma_f32_16x16x32_bf16 v[12:15], v[24:27], v[40:43], v[12:15]
v_and_b32 v20, v30, v8
v_and_b32 v21, v30, v9
v_and_b32 v22, v30, v10
v_and_b32 v23, v30, v11
s_nop 1
v_mfma_f32_16x16x32_bf16 v[12:15], v[20:23], v[44:47], v[12:15]
v_and_b32 v24, v31, v8
v_and_b32 v25, v31, v9
v_and_b32 v26, v31, v10
v_and_b32 v27, v31, v11
s_nop 1
v_mfma_f32_16x16x32_bf16 v[12:15], v[24:27], v[48:51], v[12:15]
s_cmpk_gt_u32 s61, 184
s_cbranch_scc1 L_b_162
s_cmpk_le_u32 s60, 184
s_cbranch_scc1 L_b_162_n
s_waitcnt vmcnt(3)
L_b_162_n:
s_waitcnt vmcnt(4)
L_b_162:
s_waitcnt vmcnt(5)
buffer_load_dwordx4 v[196:199], v2, s[12:15], s29 offen offset:0 nt
s_waitcnt lgkmcnt(0)
ds_read_b128 v[28:31], v4 offset:256
v_and_b32 v20, v32, v8
v_and_b32 v21, v32, v9
v_and_b32 v22, v32, v10
v_and_b32 v23, v32, v11
s_nop 1
v_mfma_f32_16x16x32_bf16 v[12:15], v[20:23], v[52:55], v[12:15]
v_and_b32 v24, v33, v8
v_and_b32 v25, v33, v9
v_and_b32 v26, v33, v10
v_and_b32 v27, v33, v11
s_nop 1
v_mfma_f32_16x16x32_bf16 v[12:15], v[24:27], v[56:59], v[12:15]
v_and_b32 v20, v34, v8
v_and_b32 v21, v34, v9
v_and_b32 v22, v34, v10
v_and_b32 v23, v34, v11
s_nop 1
v_mfma_f32_16x16x32_bf16 v[12:15], v[20:23], v[60:63], v[12:15]
v_and_b32 v24, v35, v8
v_and_b32 v25, v35, v9
v_and_b32 v26, v35, v10
v_and_b32 v27, v35, v11
s_nop 1
v_mfma_f32_16x16x32_bf16 v[12:15], v[24:27], v[64:67], v[12:15]
s_cmpk_gt_u32 s61, 185
s_cbranch_scc1 L_b_163
s_cmpk_le_u32 s60, 185
s_cbranch_scc1 L_b_163_n
s_waitcnt vmcnt(3)
L_b_163_n:
s_waitcnt vmcnt(4)
L_b_163:
s_waitcnt vmcnt(5)
buffer_load_dwordx4 v[200:203], v2, s[12:15], s29 offen offset:2048 nt
s_add_u32 s29, s29, 0x1000
s_waitcnt lgkmcnt(0)
ds_read_b128 v[32:35], v4 offset:320
v_and_b32 v20, v28, v8
v_and_b32 v21, v28, v9
v_and_b32 v22, v28, v10
v_and_b32 v23, v28, v11
s_nop 1
v_mfma_f32_16x16x32_bf16 v[12:15], v[20:23], v[68:71], v[12:15]
v_and_b32 v24, v29, v8
v_and_b32 v25, v29, v9
v_and_b32 v26, v29, v10
v_and_b32 v27, v29, v11
s_nop 1
v_mfma_f32_16x16x32_bf16 v[12:15], v[24:27], v[72:75], v[12:15]
v_and_b32 v20, v30, v8
v_and_b32 v21, v30, v9
v_and_b32 v22, v30, v10
v_and_b32 v23, v30, v11
s_nop 1
v_mfma_f32_16x16x32_bf16 v[12:15], v[20:23], v[76:79], v[12:15]
v_and_b32 v24, v31, v8
v_and_b32 v25, v31, v9
v_and_b32 v26, v31, v10
v_and_b32 v27, v31, v11
s_nop 1
v_mfma_f32_16x16x32_bf16 v[12:15], v[24:27], v[80:83], v[12:15]
s_cmpk_gt_u32 s61, 186
s_cbranch_scc1 L_b_164
s_cmpk_le_u32 s60, 186
s_cbranch_scc1 L_b_164_n
s_waitcnt vmcnt(3)
L_b_164_n:
s_waitcnt vmcnt(4)
L_b_164:
s_waitcnt vmcnt(5)
buffer_load_dwordx4 v[204:207], v2, s[12:15], s29 offen offset:0 nt
s_waitcnt lgkmcnt(0)
ds_read_b128 v[28:31], v4 offset:384
v_and_b32 v20, v32, v8
v_and_b32 v21, v32, v9
v_and_b32 v22, v32, v10
v_and_b32 v23, v32, v11
s_nop 1
v_mfma_f32_16x16x32_bf16 v[12:15], v[20:23], v[92:95], v[12:15]
v_and_b32 v24, v33, v8
v_and_b32 v25, v33, v9
v_and_b32 v26, v33, v10
v_and_b32 v27, v33, v11
s_nop 1
v_mfma_f32_16x16x32_bf16 v[12:15], v[24:27], v[112:115], v[12:15]
v_and_b32 v20, v34, v8
v_and_b32 v21, v34, v9
v_and_b32 v22, v34, v10
v_and_b32 v23, v34, v11
s_nop 1
v_mfma_f32_16x16x32_bf16 v[12:15], v[20:23], v[132:135], v[12:15]
v_and_b32 v24, v35, v8
v_and_b32 v25, v35, v9
v_and_b32 v26, v35, v10
v_and_b32 v27, v35, v11
s_nop 1
v_mfma_f32_16x16x32_bf16 v[12:15], v[24:27], v[152:155], v[12:15]
s_cmpk_gt_u32 s61, 187
s_cbranch_scc1 L_b_165
s_cmpk_le_u32 s60, 187
s_cbranch_scc1 L_b_165_n
s_waitcnt vmcnt(3)
L_b_165_n:
s_waitcnt vmcnt(4)
L_b_165:
s_waitcnt vmcnt(5)
buffer_load_dwordx4 v[208:211], v2, s[12:15], s29 offen offset:2048 nt
s_add_u32 s29, s29, 0x7f000
s_bitset0_b32 s29, 24
s_waitcnt lgkmcnt(0)
ds_read_b128 v[32:35], v4 offset:448
v_and_b32 v20, v28, v8
v_and_b32 v21, v28, v9
v_and_b32 v22, v28, v10
v_and_b32 v23, v28, v11
s_nop 1
v_mfma_f32_16x16x32_bf16 v[12:15], v[20:23], v[172:175], v[12:15]
v_and_b32 v24, v29, v8
v_and_b32 v25, v29, v9
v_and_b32 v26, v29, v10
v_and_b32 v27, v29, v11
s_nop 1
v_mfma_f32_16x16x32_bf16 v[12:15], v[24:27], v[192:195], v[12:15]
v_and_b32 v20, v30, v8
v_and_b32 v21, v30, v9
v_and_b32 v22, v30, v10
v_and_b32 v23, v30, v11
s_nop 1
v_mfma_f32_16x16x32_bf16 v[12:15], v[20:23], v[212:215], v[12:15]
v_and_b32 v24, v31, v8
v_and_b32 v25, v31, v9
v_and_b32 v26, v31, v10
v_and_b32 v27, v31, v11
s_nop 1
v_mfma_f32_16x16x32_bf16 v[12:15], v[24:27], v[224:227], v[12:15]
s_cmpk_gt_u32 s61, 188
s_cbranch_scc1 L_b_166
s_cmpk_le_u32 s60, 188
s_cbranch_scc1 L_b_166_n
s_waitcnt vmcnt(3)
L_b_166_n:
s_waitcnt vmcnt(4)
L_b_166:
s_waitcnt vmcnt(5)
buffer_load_dwordx4 v[216:219], v2, s[12:15], s29 offen offset:0 nt
s_waitcnt lgkmcnt(0)
ds_read_b128 v[28:31], v4 offset:512
v_and_b32 v20, v32, v8
v_and_b32 v21, v32, v9
v_and_b32 v22, v32, v10
v_and_b32 v23, v32, v11
s_nop 1
v_mfma_f32_16x16x32_bf16 v[12:15], v[20:23], v[228:231], v[12:15]
v_and_b32 v24, v33, v8
v_and_b32 v25, v33, v9
v_and_b32 v26, v33, v10
v_and_b32 v27, v33, v11
s_nop 1
v_mfma_f32_16x16x32_bf16 v[12:15], v[24:27], v[232:235], v[12:15]
v_and_b32 v20, v34, v8
v_and_b32 v21, v34, v9
v_and_b32 v22, v34, v10
v_and_b32 v23, v34, v11
s_nop 1
v_mfma_f32_16x16x32_bf16 v[12:15], v[20:23], v[236:239], v[12:15]
v_and_b32 v24, v35, v8
v_and_b32 v25, v35, v9
v_and_b32 v26, v35, v10
v_and_b32 v27, v35, v11
s_nop 1
v_mfma_f32_16x16x32_bf16 v[12:15], v[24:27], v[240:243], v[12:15]
s_cmpk_gt_u32 s61, 189
s_cbranch_scc1 L_b_167
s_cmpk_le_u32 s60, 189
s_cbranch_scc1 L_b_167_n
s_waitcnt vmcnt(3)
L_b_167_n:
s_waitcnt vmcnt(4)
L_b_167:
s_waitcnt vmcnt(5)
buffer_load_dwordx4 v[220:223], v2, s[12:15], s29 offen offset:2048 nt
s_add_u32 s29, s29, 0x1000
s_waitcnt lgkmcnt(0)
ds_read_b128 v[32:35], v4 offset:576
v_and_b32 v20, v28, v8
v_and_b32 v21, v28, v9
v_and_b32 v22, v28, v10
v_and_b32 v23, v28, v11
s_nop 1
v_mfma_f32_16x16x32_bf16 v[12:15], v[20:23], v[244:247], v[12:15]
v_and_b32 v24, v29, v8
v_and_b32 v25, v29, v9
v_and_b32 v26, v29, v10
v_and_b32 v27, v29, v11
s_nop 1
v_mfma_f32_16x16x32_bf16 v[12:15], v[24:27], v[248:251], v[12:15]
v_and_b32 v20, v30, v8
v_and_b32 v21, v30, v9
v_and_b32 v22, v30, v10
v_and_b32 v23, v30, v11
s_nop 1
v_mfma_f32_16x16x32_bf16 v[12:15], v[20:23], v[84:87], v[12:15]
v_and_b32 v24, v31, v8
v_and_b32 v25, v31, v9
v_and_b32 v26, v31, v10
v_and_b32 v27, v31, v11
s_nop 1
v_mfma_f32_16x16x32_bf16 v[12:15], v[24:27], v[88:91], v[12:15]
s_cmpk_gt_u32 s61, 190
s_cbranch_scc1 L_b_168
s_cmpk_le_u32 s60, 190
s_cbranch_scc1 L_b_168_n
s_waitcnt vmcnt(3)
L_b_168_n:
s_waitcnt vmcnt(4)
L_b_168:
s_waitcnt vmcnt(5)
buffer_load_dwordx4 v[36:39], v2, s[12:15], s29 offen offset:0 nt
s_waitcnt lgkmcnt(0)
ds_read_b128 v[28:31], v4 offset:640
v_and_b32 v20, v32, v8
v_and_b32 v21, v32, v9
v_and_b32 v22, v32, v10
v_and_b32 v23, v32, v11
s_nop 1
v_mfma_f32_16x16x32_bf16 v[12:15], v[20:23], v[96:99], v[12:15]
v_and_b32 v24, v33, v8
v_and_b32 v25, v33, v9
v_and_b32 v26, v33, v10
v_and_b32 v27, v33, v11
s_nop 1
v_mfma_f32_16x16x32_bf16 v[12:15], v[24:27], v[100:103], v[12:15]
v_and_b32 v20, v34, v8
v_and_b32 v21, v34, v9
v_and_b32 v22, v34, v10
v_and_b32 v23, v34, v11
s_nop 1
v_mfma_f32_16x16x32_bf16 v[12:15], v[20:23], v[104:107], v[12:15]
v_and_b32 v24, v35, v8
v_and_b32 v25, v35, v9
v_and_b32 v26, v35, v10
v_and_b32 v27, v35, v11
s_nop 1
v_mfma_f32_16x16x32_bf16 v[12:15], v[24:27], v[108:111], v[12:15]
s_cmpk_gt_u32 s61, 191
s_cbranch_scc1 L_b_169
s_cmpk_le_u32 s60, 191
s_cbranch_scc1 L_b_169_n
s_waitcnt vmcnt(3)
L_b_169_n:
s_waitcnt vmcnt(4)
L_b_169:
s_waitcnt vmcnt(5)
buffer_load_dwordx4 v[40:43], v2, s[12:15], s29 offen offset:2048 nt
s_add_u32 s29, s29, 0x7f000
s_bitset0_b32 s29, 24
s_waitcnt lgkmcnt(0)
ds_read_b128 v[32:35], v4 offset:704
v_and_b32 v20, v28, v8
v_and_b32 v21, v28, v9
v_and_b32 v22, v28, v10
v_and_b32 v23, v28, v11
s_nop 1
v_mfma_f32_16x16x32_bf16 v[12:15], v[20:23], v[116:119], v[12:15]
v_and_b32 v24, v29, v8
v_and_b32 v25, v29, v9
v_and_b32 v26, v29, v10
v_and_b32 v27, v29, v11
s_nop 1
v_mfma_f32_16x16x32_bf16 v[12:15], v[24:27], v[120:123], v[12:15]
v_and_b32 v20, v30, v8
v_and_b32 v21, v30, v9
v_and_b32 v22, v30, v10
v_and_b32 v23, v30, v11
s_nop 1
v_mfma_f32_16x16x32_bf16 v[12:15], v[20:23], v[124:127], v[12:15]
v_and_b32 v24, v31, v8
v_and_b32 v25, v31, v9
v_and_b32 v26, v31, v10
v_and_b32 v27, v31, v11
s_nop 1
v_mfma_f32_16x16x32_bf16 v[12:15], v[24:27], v[128:131], v[12:15]
s_cmpk_gt_u32 s61, 192
s_cbranch_scc1 L_b_170
s_cmpk_le_u32 s60, 192
s_cbranch_scc1 L_b_170_n
s_waitcnt vmcnt(3)
L_b_170_n:
s_waitcnt vmcnt(4)
L_b_170:
s_waitcnt vmcnt(5)
buffer_load_dwordx4 v[44:47], v2, s[12:15], s29 offen offset:0 nt
s_waitcnt lgkmcnt(0)
ds_read_b128 v[28:31], v4 offset:768
v_and_b32 v20, v32, v8
v_and_b32 v21, v32, v9
v_and_b32 v22, v32, v10
v_and_b32 v23, v32, v11
s_nop 1
v_mfma_f32_16x16x32_bf16 v[12:15], v[20:23], v[136:139], v[12:15]
v_and_b32 v24, v33, v8
v_and_b32 v25, v33, v9
v_and_b32 v26, v33, v10
v_and_b32 v27, v33, v11
s_nop 1
v_mfma_f32_16x16x32_bf16 v[12:15], v[24:27], v[140:143], v[12:15]
v_and_b32 v20, v34, v8
v_and_b32 v21, v34, v9
v_and_b32 v22, v34, v10
v_and_b32 v23, v34, v11
s_nop 1
v_mfma_f32_16x16x32_bf16 v[12:15], v[20:23], v[144:147], v[12:15]
v_and_b32 v24, v35, v8
v_and_b32 v25, v35, v9
v_and_b32 v26, v35, v10
v_and_b32 v27, v35, v11
s_nop 1
v_mfma_f32_16x16x32_bf16 v[12:15], v[24:27], v[148:151], v[12:15]
s_cmpk_gt_u32 s61, 193
s_cbranch_scc1 L_b_171
s_cmpk_le_u32 s60, 193
s_cbranch_scc1 L_b_171_n
s_waitcnt vmcnt(3)
L_b_171_n:
s_waitcnt vmcnt(4)
L_b_171:
s_waitcnt vmcnt(5)
buffer_load_dwordx4 v[48:51], v2, s[12:15], s29 offen offset:2048 nt
s_add_u32 s29, s29, 0x1000
s_waitcnt lgkmcnt(0)
ds_read_b128 v[32:35], v4 offset:832
v_and_b32 v20, v28, v8
v_and_b32 v21, v28, v9
v_and_b32 v22, v28, v10
v_and_b32 v23, v28, v11
s_nop 1
v_mfma_f32_16x16x32_bf16 v[12:15], v[20:23], v[156:159], v[12:15]
v_and_b32 v24, v29, v8
v_and_b32 v25, v29, v9
v_and_b32 v26, v29, v10
v_and_b32 v27, v29, v11
s_nop 1
v_mfma_f32_16x16x32_bf16 v[12:15], v[24:27], v[160:163], v[12:15]
v_and_b32 v20, v30, v8
v_and_b32 v21, v30, v9
v_and_b32 v22, v30, v10
v_and_b32 v23, v30, v11
s_nop 1
v_mfma_f32_16x16x32_bf16 v[12:15], v[20:23], v[164:167], v[12:15]
v_and_b32 v24, v31, v8
v_and_b32 v25, v31, v9
v_and_b32 v26, v31, v10
v_and_b32 v27, v31, v11
s_nop 1
v_mfma_f32_16x16x32_bf16 v[12:15], v[24:27], v[168:171], v[12:15]
s_cmpk_gt_u32 s61, 194
s_cbranch_scc1 L_b_172
s_cmpk_le_u32 s60, 194
s_cbranch_scc1 L_b_172_n
s_waitcnt vmcnt(3)
L_b_172_n:
s_waitcnt vmcnt(4)
L_b_172:
s_waitcnt vmcnt(5)
buffer_load_dwordx4 v[52:55], v2, s[12:15], s29 offen offset:0 nt
s_waitcnt lgkmcnt(0)
ds_read_b128 v[28:31], v4 offset:896
v_and_b32 v20, v32, v8
v_and_b32 v21, v32, v9
v_and_b32 v22, v32, v10
v_and_b32 v23, v32, v11
s_nop 1
v_mfma_f32_16x16x32_bf16 v[12:15], v[20:23], v[176:179], v[12:15]
v_and_b32 v24, v33, v8
v_and_b32 v25, v33, v9
v_and_b32 v26, v33, v10
v_and_b32 v27, v33, v11
s_nop 1
v_mfma_f32_16x16x32_bf16 v[12:15], v[24:27], v[180:183], v[12:15]
v_and_b32 v20, v34, v8
v_and_b32 v21, v34, v9
v_and_b32 v22, v34, v10
v_and_b32 v23, v34, v11
s_nop 1
v_mfma_f32_16x16x32_bf16 v[12:15], v[20:23], v[184:187], v[12:15]
v_and_b32 v24, v35, v8
v_and_b32 v25, v35, v9
v_and_b32 v26, v35, v10
v_and_b32 v27, v35, v11
s_nop 1
v_mfma_f32_16x16x32_bf16 v[12:15], v[24:27], v[188:191], v[12:15]
s_cmpk_gt_u32 s61, 195
s_cbranch_scc1 L_b_173
s_cmpk_le_u32 s60, 195
s_cbranch_scc1 L_b_173_n
s_waitcnt vmcnt(3)
L_b_173_n:
s_waitcnt vmcnt(4)
L_b_173:
s_waitcnt vmcnt(5)
buffer_load_dwordx4 v[56:59], v2, s[12:15], s29 offen offset:2048 nt
s_add_u32 s29, s29, 0x7f000
s_bitset0_b32 s29, 24
s_waitcnt lgkmcnt(0)
ds_read_b128 v[32:35], v4 offset:960
v_and_b32 v20, v28, v8
v_and_b32 v21, v28, v9
v_and_b32 v22, v28, v10
v_and_b32 v23, v28, v11
s_nop 1
v_mfma_f32_16x16x32_bf16 v[12:15], v[20:23], v[196:199], v[12:15]
v_and_b32 v24, v29, v8
v_and_b32 v25, v29, v9
v_and_b32 v26, v29, v10
v_and_b32 v27, v29, v11
s_nop 1
v_mfma_f32_16x16x32_bf16 v[12:15], v[24:27], v[200:203], v[12:15]
v_and_b32 v20, v30, v8
v_and_b32 v21, v30, v9
v_and_b32 v22, v30, v10
v_and_b32 v23, v30, v11
s_nop 1
v_mfma_f32_16x16x32_bf16 v[12:15], v[20:23], v[204:207], v[12:15]
v_and_b32 v24, v31, v8
v_and_b32 v25, v31, v9
v_and_b32 v26, v31, v10
v_and_b32 v27, v31, v11
s_nop 1
v_mfma_f32_16x16x32_bf16 v[12:15], v[24:27], v[208:211], v[12:15]
s_cmpk_gt_u32 s61, 196
s_cbranch_scc1 L_b_174
s_cmpk_le_u32 s60, 196
s_cbranch_scc1 L_b_174_n
s_waitcnt vmcnt(3)
L_b_174_n:
s_waitcnt vmcnt(4)
L_b_174:
s_waitcnt vmcnt(5)
buffer_load_dwordx4 v[60:63], v2, s[12:15], s29 offen offset:0 nt
s_waitcnt lgkmcnt(0)
ds_read_b128 v[28:31], v4 offset:1024
v_and_b32 v20, v32, v8
v_and_b32 v21, v32, v9
v_and_b32 v22, v32, v10
v_and_b32 v23, v32, v11
s_nop 1
v_mfma_f32_16x16x32_bf16 v[12:15], v[20:23], v[216:219], v[12:15]
v_and_b32 v24, v33, v8
v_and_b32 v25, v33, v9
v_and_b32 v26, v33, v10
v_and_b32 v27, v33, v11
s_nop 1
v_mfma_f32_16x16x32_bf16 v[12:15], v[24:27], v[220:223], v[12:15]
v_and_b32 v20, v34, v8
v_and_b32 v21, v34, v9
v_and_b32 v22, v34, v10
v_and_b32 v23, v34, v11
s_nop 1
v_mfma_f32_16x16x32_bf16 v[12:15], v[20:23], v[36:39], v[12:15]
s_cmpk_gt_u32 s61, 197
s_cbranch_scc1 L_b_175
s_cmpk_le_u32 s60, 197
s_cbranch_scc1 L_b_175_n
s_waitcnt vmcnt(3)
L_b_175_n:
s_waitcnt vmcnt(4)
L_b_175:
s_waitcnt vmcnt(5)
buffer_load_dwordx4 v[64:67], v2, s[12:15], s29 offen offset:2048 nt
s_add_u32 s29, s29, 0x1000
v_and_b32 v24, v35, v8
v_and_b32 v25, v35, v9
v_and_b32 v26, v35, v10
v_and_b32 v27, v35, v11
s_nop 1
v_mfma_f32_16x16x32_bf16 v[12:15], v[24:27], v[40:43], v[12:15]
s_cmpk_gt_u32 s61, 198
s_cbranch_scc1 L_b_176
s_cmpk_le_u32 s60, 198
s_cbranch_scc1 L_b_176_n
s_waitcnt vmcnt(3)
L_b_176_n:
s_waitcnt vmcnt(4)
L_b_176:
s_waitcnt vmcnt(5)
buffer_load_dwordx4 v[68:71], v2, s[12:15], s29 offen offset:0 nt
s_waitcnt lgkmcnt(0)
ds_read_b128 v[32:35], v4 offset:1088
v_and_b32 v20, v28, v8
v_and_b32 v21, v28, v9
v_and_b32 v22, v28, v10
v_and_b32 v23, v28, v11
s_nop 1
v_mfma_f32_16x16x32_bf16 v[12:15], v[20:23], v[44:47], v[12:15]
s_cmpk_gt_u32 s61, 199
s_cbranch_scc1 L_b_177
s_cmpk_le_u32 s60, 199
s_cbranch_scc1 L_b_177_n
s_waitcnt vmcnt(3)
L_b_177_n:
s_waitcnt vmcnt(4)
L_b_177:
s_waitcnt vmcnt(5)
buffer_load_dwordx4 v[72:75], v2, s[12:15], s29 offen offset:2048 nt
s_add_u32 s29, s29, 0x7f000
s_bitset0_b32 s29, 24
v_and_b32 v24, v29, v8
v_and_b32 v25, v29, v9
v_and_b32 v26, v29, v10
v_and_b32 v27, v29, v11
s_nop 1
v_mfma_f32_16x16x32_bf16 v[12:15], v[24:27], v[48:51], v[12:15]
s_cmpk_gt_u32 s61, 200
s_cbranch_scc1 L_b_178
s_cmpk_le_u32 s60, 200
s_cbranch_scc1 L_b_178_n
s_waitcnt vmcnt(3)
L_b_178_n:
s_waitcnt vmcnt(4)
L_b_178:
s_waitcnt vmcnt(5)
buffer_load_dwordx4 v[76:79], v2, s[12:15], s29 offen offset:0 nt
v_mov_b32 v6, 200
s_mov_b64 exec, 1
ds_max_u32 v7, v6 offset:12
s_mov_b64 exec, -1
s_cmp_lg_u32 s64, 0
s_cbranch_scc1 L_c_179
v_mov_b32 v6, 1
s_mov_b64 exec, 1
ds_add_rtn_u32 v253, v7, v6 offset:76
s_mov_b64 exec, -1
L_c_179:
v_and_b32 v20, v30, v8
v_and_b32 v21, v30, v9
v_and_b32 v22, v30, v10
v_and_b32 v23, v30, v11
s_nop 1
v_mfma_f32_16x16x32_bf16 v[12:15], v[20:23], v[52:55], v[12:15]
s_cmpk_gt_u32 s61, 201
s_cbranch_scc1 L_b_180
s_cmpk_le_u32 s60, 201
s_cbranch_scc1 L_b_180_n
s_waitcnt vmcnt(3)
L_b_180_n:
s_waitcnt vmcnt(4)
L_b_180:
s_waitcnt vmcnt(5)
buffer_load_dwordx4 v[80:83], v2, s[12:15], s29 offen offset:2048 nt
s_add_u32 s29, s29, 0x1000
v_and_b32 v24, v31, v8
v_and_b32 v25, v31, v9
v_and_b32 v26, v31, v10
v_and_b32 v27, v31, v11
s_nop 1
v_mfma_f32_16x16x32_bf16 v[12:15], v[24:27], v[56:59], v[12:15]
s_cmpk_gt_u32 s61, 202
s_cbranch_scc1 L_b_181
s_cmpk_le_u32 s60, 202
s_cbranch_scc1 L_b_181_n
s_waitcnt vmcnt(3)
L_b_181_n:
s_waitcnt vmcnt(4)
L_b_181:
s_waitcnt vmcnt(5)
buffer_load_dwordx4 v[92:95], v2, s[12:15], s29 offen offset:0 nt
s_waitcnt lgkmcnt(0)
ds_read_b128 v[28:31], v4 offset:1152
v_and_b32 v20, v32, v8
v_and_b32 v21, v32, v9
v_and_b32 v22, v32, v10
v_and_b32 v23, v32, v11
s_nop 1
v_mfma_f32_16x16x32_bf16 v[12:15], v[20:23], v[60:63], v[12:15]
s_cmpk_gt_u32 s61, 203
s_cbranch_scc1 L_b_182
s_cmpk_le_u32 s60, 203
s_cbranch_scc1 L_b_182_n
s_waitcnt vmcnt(3)
L_b_182_n:
s_waitcnt vmcnt(4)
L_b_182:
s_waitcnt vmcnt(5)
buffer_load_dwordx4 v[112:115], v2, s[12:15], s29 offen offset:2048 nt
s_add_u32 s29, s29, 0x7f000
s_bitset0_b32 s29, 24
v_and_b32 v24, v33, v8
v_and_b32 v25, v33, v9
v_and_b32 v26, v33, v10
v_and_b32 v27, v33, v11
s_nop 1
v_mfma_f32_16x16x32_bf16 v[12:15], v[24:27], v[64:67], v[12:15]
s_cmpk_gt_u32 s61, 204
s_cbranch_scc1 L_b_183
s_cmpk_le_u32 s60, 204
s_cbranch_scc1 L_b_183_n
s_waitcnt vmcnt(3)
L_b_183_n:
s_waitcnt vmcnt(4)
L_b_183:
s_waitcnt vmcnt(5)
buffer_load_dwordx4 v[132:135], v2, s[12:15], s29 offen offset:0 nt
s_cmp_lg_u32 s64, 1
s_cbranch_scc1 L_c_184
v_mov_b32 v6, 1
s_mov_b64 exec, 1
ds_add_rtn_u32 v253, v7, v6 offset:76
s_mov_b64 exec, -1
L_c_184:
v_and_b32 v20, v34, v8
v_and_b32 v21, v34, v9
v_and_b32 v22, v34, v10
v_and_b32 v23, v34, v11
s_nop 1
v_mfma_f32_16x16x32_bf16 v[12:15], v[20:23], v[68:71], v[12:15]
s_cmpk_gt_u32 s61, 205
s_cbranch_scc1 L_b_185
s_cmpk_le_u32 s60, 205
s_cbranch_scc1 L_b_185_n
s_waitcnt vmcnt(3)
L_b_185_n:
s_waitcnt vmcnt(4)
L_b_185:
s_waitcnt vmcnt(5)
buffer_load_dwordx4 v[152:155], v2, s[12:15], s29 offen offset:2048 nt
s_add_u32 s29, s29, 0x1000
v_and_b32 v24, v35, v8
v_and_b32 v25, v35, v9
v_and_b32 v26, v35, v10
v_and_b32 v27, v35, v11
s_nop 1
v_mfma_f32_16x16x32_bf16 v[12:15], v[24:27], v[72:75], v[12:15]
s_cmpk_gt_u32 s61, 206
s_cbranch_scc1 L_b_186
s_cmpk_le_u32 s60, 206
s_cbranch_scc1 L_b_186_n
s_waitcnt vmcnt(3)
L_b_186_n:
s_waitcnt vmcnt(4)
L_b_186:
s_waitcnt vmcnt(5)
buffer_load_dwordx4 v[172:175], v2, s[12:15], s29 offen offset:0 nt
s_cmp_lg_u32 s64, 0
s_cbranch_scc1 L_c_187
ds_read_b32 v254, v7 offset:140
L_c_187:
s_waitcnt lgkmcnt(0)
ds_read_b128 v[32:35], v4 offset:1216
v_and_b32 v20, v28, v8
v_and_b32 v21, v28, v9
v_and_b32 v22, v28, v10
v_and_b32 v23, v28, v11
s_nop 1
v_mfma_f32_16x16x32_bf16 v[12:15], v[20:23], v[76:79], v[12:15]
s_lshl_b32 s7, s3, 10
s_add_u32 s7, s7, 24576
v_lshl_add_u32 v3, v0, 4, s7
v_xor_b32 v1, 0x800, v3
s_lshl_b32 s7, s24, 2
v_mov_b32 v16, s7
v_mov_b32 v17, 1
v_lshrrev_b32 v5, 5, v0
v_bfe_u32 v6, v0, 1, 3
v_lshl_add_u32 v5, v5, 4, v6
v_mul_u32_u24 v5, 2176, v5
v_and_b32 v6, 1, v0
v_lshl_add_u32 v5, v6, 5, v5
v_bfe_u32 v6, v0, 4, 1
v_lshl_add_u32 v18, v6, 4, v5
s_lshl_b32 s28, s4, 2
s_add_u32 s28, s28, s24
s_mul_i32 s28, s28, 17408
s_lshl_b32 s7, s5, 6
s_add_u32 s28, s28, s7
s_add_u32 s28, s28, 131072
s_cmpk_gt_u32 s61, 207
s_cbranch_scc1 L_b_188
s_cmpk_le_u32 s60, 207
s_cbranch_scc1 L_b_188_n
s_waitcnt vmcnt(3)
L_b_188_n:
s_waitcnt vmcnt(4)
L_b_188:
s_waitcnt vmcnt(5)
buffer_load_dwordx4 v[192:195], v2, s[12:15], s29 offen offset:2048 nt
s_add_u32 s29, s29, 0x7f000
s_bitset0_b32 s29, 24
s_cmp_lg_u32 s64, 0
s_cbranch_scc1 L_c_189
s_waitcnt lgkmcnt(0)
v_readfirstlane_b32 s7, v253
v_readfirstlane_b32 s65, v254
s_mul_i32 s7, s7, 3
s_sub_u32 s7, s7, 4
s_add_u32 s7, s7, s65
s_add_u32 s61, s7, 208
s_sub_u32 s60, 208, s7
L_c_189:
v_and_b32 v24, v29, v8
v_and_b32 v25, v29, v9
v_and_b32 v26, v29, v10
v_and_b32 v27, v29, v11
s_nop 1
v_mfma_f32_16x16x32_bf16 v[12:15], v[24:27], v[80:83], v[12:15]
s_cmpk_gt_u32 s61, 208
s_cbranch_scc1 L_b_190
s_cmpk_le_u32 s60, 208
s_cbranch_scc1 L_b_190_n
s_waitcnt vmcnt(3)
L_b_190_n:
s_waitcnt vmcnt(4)
L_b_190:
s_waitcnt vmcnt(5)
buffer_load_dwordx4 v[212:215], v2, s[12:15], s29 offen offset:0 nt
v_and_b32 v20, v30, v8
v_and_b32 v21, v30, v9
v_and_b32 v22, v30, v10
v_and_b32 v23, v30, v11
s_nop 1
v_mfma_f32_16x16x32_bf16 v[12:15], v[20:23], v[92:95], v[12:15]
s_cmpk_gt_u32 s61, 209
s_cbranch_scc1 L_b_191
s_cmpk_le_u32 s60, 209
s_cbranch_scc1 L_b_191_n
s_waitcnt vmcnt(3)
L_b_191_n:
s_waitcnt vmcnt(4)
L_b_191:
s_waitcnt vmcnt(5)
buffer_load_dwordx4 v[224:227], v2, s[12:15], s29 offen offset:2048 nt
s_add_u32 s29, s29, 0x1000
v_and_b32 v24, v31, v8
v_and_b32 v25, v31, v9
v_and_b32 v26, v31, v10
v_and_b32 v27, v31, v11
s_nop 1
v_mfma_f32_16x16x32_bf16 v[12:15], v[24:27], v[112:115], v[12:15]
s_cmpk_gt_u32 s61, 210
s_cbranch_scc1 L_b_192
s_cmpk_le_u32 s60, 210
s_cbranch_scc1 L_b_192_n
s_waitcnt vmcnt(3)
L_b_192_n:
s_waitcnt vmcnt(4)
L_b_192:
s_waitcnt vmcnt(5)
buffer_load_dwordx4 v[228:231], v2, s[12:15], s29 offen offset:0 nt
s_cmp_lg_u32 s64, 0
s_cbranch_scc1 L_c_193
ds_read_b32 v254, v7 offset:140
L_c_193:
s_cmp_lg_u32 s64, 1
s_cbranch_scc1 L_c_194
ds_read_b32 v254, v7 offset:140
L_c_194:
s_waitcnt lgkmcnt(0)
ds_read_b128 v[28:31], v4 offset:1280
v_and_b32 v20, v32, v8
v_and_b32 v21, v32, v9
v_and_b32 v22, v32, v10
v_and_b32 v23, v32, v11
s_nop 1
v_mfma_f32_16x16x32_bf16 v[12:15], v[20:23], v[132:135], v[12:15]
s_cmpk_gt_u32 s61, 211
s_cbranch_scc1 L_b_195
s_cmpk_le_u32 s60, 211
s_cbranch_scc1 L_b_195_n
s_waitcnt vmcnt(3)
L_b_195_n:
s_waitcnt vmcnt(4)
L_b_195:
s_waitcnt vmcnt(5)
buffer_load_dwordx4 v[232:235], v2, s[12:15], s29 offen offset:2048 nt
s_add_u32 s29, s29, 0x7f000
s_bitset0_b32 s29, 24
s_cmp_lg_u32 s64, 0
s_cbranch_scc1 L_c_196
s_waitcnt lgkmcnt(0)
v_readfirstlane_b32 s7, v253
v_readfirstlane_b32 s65, v254
s_mul_i32 s7, s7, 3
s_sub_u32 s7, s7, 4
s_add_u32 s7, s7, s65
s_add_u32 s61, s7, 208
s_sub_u32 s60, 208, s7
L_c_196:
s_cmp_lg_u32 s64, 1
s_cbranch_scc1 L_c_197
s_waitcnt lgkmcnt(0)
v_readfirstlane_b32 s7, v253
v_readfirstlane_b32 s65, v254
s_mul_i32 s7, s7, 3
s_sub_u32 s7, s7, 4
s_add_u32 s7, s7, s65
s_add_u32 s61, s7, 212
s_sub_u32 s60, 212, s7
L_c_197:
v_and_b32 v24, v33, v8
v_and_b32 v25, v33, v9
v_and_b32 v26, v33, v10
v_and_b32 v27, v33, v11
s_nop 1
v_mfma_f32_16x16x32_bf16 v[12:15], v[24:27], v[152:155], v[12:15]
s_cmpk_gt_u32 s61, 212
s_cbranch_scc1 L_b_198
s_cmpk_le_u32 s60, 212
s_cbranch_scc1 L_b_198_n
s_waitcnt vmcnt(3)
L_b_198_n:
s_waitcnt vmcnt(4)
L_b_198:
s_waitcnt vmcnt(5)
buffer_load_dwordx4 v[236:239], v2, s[12:15], s29 offen offset:0 nt
v_and_b32 v20, v34, v8
v_and_b32 v21, v34, v9
v_and_b32 v22, v34, v10
v_and_b32 v23, v34, v11
s_nop 1
v_mfma_f32_16x16x32_bf16 v[12:15], v[20:23], v[172:175], v[12:15]
s_cmpk_gt_u32 s61, 213
s_cbranch_scc1 L_b_199
s_cmpk_le_u32 s60, 213
s_cbranch_scc1 L_b_199_n
s_waitcnt vmcnt(3)
L_b_199_n:
s_waitcnt vmcnt(4)
L_b_199:
s_waitcnt vmcnt(5)
buffer_load_dwordx4 v[240:243], v2, s[12:15], s29 offen offset:2048 nt
s_add_u32 s29, s29, 0x1000
v_and_b32 v24, v35, v8
v_and_b32 v25, v35, v9
v_and_b32 v26, v35, v10
v_and_b32 v27, v35, v11
s_nop 1
v_mfma_f32_16x16x32_bf16 v[12:15], v[24:27], v[192:195], v[12:15]
s_cmpk_gt_u32 s61, 214
s_cbranch_scc1 L_b_200
s_cmpk_le_u32 s60, 214
s_cbranch_scc1 L_b_200_n
s_waitcnt vmcnt(3)
L_b_200_n:
s_waitcnt vmcnt(4)
L_b_200:
s_waitcnt vmcnt(5)
buffer_load_dwordx4 v[244:247], v2, s[12:15], s29 offen offset:0 nt
v_mov_b32 v6, 214
s_mov_b64 exec, 1
ds_max_u32 v7, v6 offset:12
s_mov_b64 exec, -1
s_cmp_lg_u32 s64, 1
s_cbranch_scc1 L_c_201
ds_read_b32 v254, v7 offset:140
L_c_201:
s_waitcnt lgkmcnt(0)
ds_read_b128 v[32:35], v4 offset:1344
v_and_b32 v20, v28, v8
v_and_b32 v21, v28, v9
v_and_b32 v22, v28, v10
v_and_b32 v23, v28, v11
s_nop 1
v_mfma_f32_16x16x32_bf16 v[12:15], v[20:23], v[212:215], v[12:15]
s_cmpk_gt_u32 s61, 215
s_cbranch_scc1 L_b_202
s_cmpk_le_u32 s60, 215
s_cbranch_scc1 L_b_202_n
s_waitcnt vmcnt(3)
L_b_202_n:
s_waitcnt vmcnt(4)
L_b_202:
s_waitcnt vmcnt(5)
buffer_load_dwordx4 v[248:251], v2, s[12:15], s29 offen offset:2048 nt
s_add_u32 s29, s29, 0x7f000
s_bitset0_b32 s29, 24
s_cmp_lg_u32 s64, 1
s_cbranch_scc1 L_c_203
s_waitcnt lgkmcnt(0)
v_readfirstlane_b32 s7, v253
v_readfirstlane_b32 s65, v254
s_mul_i32 s7, s7, 3
s_sub_u32 s7, s7, 4
s_add_u32 s7, s7, s65
s_add_u32 s61, s7, 212
s_sub_u32 s60, 212, s7
L_c_203:
v_and_b32 v24, v29, v8
v_and_b32 v25, v29, v9
v_and_b32 v26, v29, v10
v_and_b32 v27, v29, v11
s_nop 1
v_mfma_f32_16x16x32_bf16 v[12:15], v[24:27], v[224:227], v[12:15]
s_cmpk_gt_u32 s61, 216
s_cbranch_scc1 L_b_204
s_cmpk_le_u32 s60, 216
s_cbranch_scc1 L_b_204_n
s_waitcnt vmcnt(3)
L_b_204_n:
s_waitcnt vmcnt(4)
L_b_204:
s_waitcnt vmcnt(5)
buffer_load_dwordx4 v[84:87], v2, s[12:15], s29 offen offset:0 nt
v_and_b32 v20, v30, v8
v_and_b32 v21, v30, v9
v_and_b32 v22, v30, v10
v_and_b32 v23, v30, v11
s_nop 1
v_mfma_f32_16x16x32_bf16 v[12:15], v[20:23], v[228:231], v[12:15]
s_cmpk_gt_u32 s61, 217
s_cbranch_scc1 L_b_205
s_cmpk_le_u32 s60, 217
s_cbranch_scc1 L_b_205_n
s_waitcnt vmcnt(3)
L_b_205_n:
s_waitcnt vmcnt(4)
L_b_205:
s_waitcnt vmcnt(5)
buffer_load_dwordx4 v[88:91], v2, s[12:15], s29 offen offset:2048 nt
s_add_u32 s29, s29, 0x1000
v_and_b32 v24, v31, v8
v_and_b32 v25, v31, v9
v_and_b32 v26, v31, v10
v_and_b32 v27, v31, v11
s_nop 1
v_mfma_f32_16x16x32_bf16 v[12:15], v[24:27], v[232:235], v[12:15]
s_cmpk_gt_u32 s61, 218
s_cbranch_scc1 L_b_206
s_cmpk_le_u32 s60, 218
s_cbranch_scc1 L_b_206_n
s_waitcnt vmcnt(3)
L_b_206_n:
s_waitcnt vmcnt(4)
L_b_206:
s_waitcnt vmcnt(5)
buffer_load_dwordx4 v[96:99], v2, s[12:15], s29 offen offset:0 nt
s_waitcnt lgkmcnt(0)
ds_read_b128 v[28:31], v4 offset:1408
v_and_b32 v20, v32, v8
v_and_b32 v21, v32, v9
v_and_b32 v22, v32, v10
v_and_b32 v23, v32, v11
s_nop 1
v_mfma_f32_16x16x32_bf16 v[12:15], v[20:23], v[236:239], v[12:15]
s_cmpk_gt_u32 s61, 219
s_cbranch_scc1 L_b_207
s_cmpk_le_u32 s60, 219
s_cbranch_scc1 L_b_207_n
s_waitcnt vmcnt(3)
L_b_207_n:
s_waitcnt vmcnt(4)
L_b_207:
s_waitcnt vmcnt(5)
buffer_load_dwordx4 v[100:103], v2, s[12:15], s29 offen offset:2048 nt
s_add_u32 s29, s29, 0x7f000
s_bitset0_b32 s29, 24
v_and_b32 v24, v33, v8
v_and_b32 v25, v33, v9
v_and_b32 v26, v33, v10
v_and_b32 v27, v33, v11
s_nop 1
v_mfma_f32_16x16x32_bf16 v[12:15], v[24:27], v[240:243], v[12:15]
s_cmpk_gt_u32 s61, 220
s_cbranch_scc1 L_b_208
s_cmpk_le_u32 s60, 220
s_cbranch_scc1 L_b_208_n
s_waitcnt vmcnt(3)
L_b_208_n:
s_waitcnt vmcnt(4)
L_b_208:
s_waitcnt vmcnt(5)
buffer_load_dwordx4 v[104:107], v2, s[12:15], s29 offen offset:0 nt
v_and_b32 v20, v34, v8
v_and_b32 v21, v34, v9
v_and_b32 v22, v34, v10
v_and_b32 v23, v34, v11
s_nop 1
v_mfma_f32_16x16x32_bf16 v[12:15], v[20:23], v[244:247], v[12:15]
s_cmpk_gt_u32 s61, 221
s_cbranch_scc1 L_b_209
s_cmpk_le_u32 s60, 221
s_cbranch_scc1 L_b_209_n
s_waitcnt vmcnt(3)
L_b_209_n:
s_waitcnt vmcnt(4)
L_b_209:
s_waitcnt vmcnt(5)
buffer_load_dwordx4 v[108:111], v2, s[12:15], s29 offen offset:2048 nt
s_add_u32 s29, s29, 0x1000
v_and_b32 v24, v35, v8
v_and_b32 v25, v35, v9
v_and_b32 v26, v35, v10
v_and_b32 v27, v35, v11
s_nop 1
v_mfma_f32_16x16x32_bf16 v[12:15], v[24:27], v[248:251], v[12:15]
s_cmpk_gt_u32 s61, 222
s_cbranch_scc1 L_b_210
s_cmpk_le_u32 s60, 222
s_cbranch_scc1 L_b_210_n
s_waitcnt vmcnt(3)
L_b_210_n:
s_waitcnt vmcnt(4)
L_b_210:
s_waitcnt vmcnt(5)
buffer_load_dwordx4 v[116:119], v2, s[12:15], s29 offen offset:0 nt
s_cmp_lg_u32 s64, 0
s_cbranch_scc1 L_c_211
v_mov_b32 v6, 1
s_mov_b64 exec, 1
ds_add_rtn_u32 v253, v7, v6 offset:80
s_mov_b64 exec, -1
L_c_211:
s_waitcnt lgkmcnt(0)
ds_read_b128 v[32:35], v4 offset:1472
v_and_b32 v20, v28, v8
v_and_b32 v21, v28, v9
v_and_b32 v22, v28, v10
v_and_b32 v23, v28, v11
s_nop 1
v_mfma_f32_16x16x32_bf16 v[12:15], v[20:23], v[84:87], v[12:15]
s_cmpk_gt_u32 s61, 223
s_cbranch_scc1 L_b_212
s_cmpk_le_u32 s60, 223
s_cbranch_scc1 L_b_212_n
s_waitcnt vmcnt(3)
L_b_212_n:
s_waitcnt vmcnt(4)
L_b_212:
s_waitcnt vmcnt(5)
buffer_load_dwordx4 v[120:123], v2, s[12:15], s29 offen offset:2048 nt
s_add_u32 s29, s29, 0x7f000
s_bitset0_b32 s29, 24
v_and_b32 v24, v29, v8
v_and_b32 v25, v29, v9
v_and_b32 v26, v29, v10
v_and_b32 v27, v29, v11
s_nop 1
v_mfma_f32_16x16x32_bf16 v[12:15], v[24:27], v[88:91], v[12:15]
s_cmpk_gt_u32 s61, 224
s_cbranch_scc1 L_b_213
s_cmpk_le_u32 s60, 224
s_cbranch_scc1 L_b_213_n
s_waitcnt vmcnt(3)
L_b_213_n:
s_waitcnt vmcnt(4)
L_b_213:
s_waitcnt vmcnt(5)
buffer_load_dwordx4 v[124:127], v2, s[12:15], s29 offen offset:0 nt
v_and_b32 v20, v30, v8
v_and_b32 v21, v30, v9
v_and_b32 v22, v30, v10
v_and_b32 v23, v30, v11
s_nop 1
v_mfma_f32_16x16x32_bf16 v[12:15], v[20:23], v[96:99], v[12:15]
s_cmpk_gt_u32 s61, 225
s_cbranch_scc1 L_b_214
s_cmpk_le_u32 s60, 225
s_cbranch_scc1 L_b_214_n
s_waitcnt vmcnt(3)
L_b_214_n:
s_waitcnt vmcnt(4)
L_b_214:
s_waitcnt vmcnt(5)
buffer_load_dwordx4 v[128:131], v2, s[12:15], s29 offen offset:2048 nt
s_add_u32 s29, s29, 0x1000
v_and_b32 v24, v31, v8
v_and_b32 v25, v31, v9
v_and_b32 v26, v31, v10
v_and_b32 v27, v31, v11
s_nop 1
v_mfma_f32_16x16x32_bf16 v[12:15], v[24:27], v[100:103], v[12:15]
s_cmpk_gt_u32 s61, 226
s_cbranch_scc1 L_b_215
s_cmpk_le_u32 s60, 226
s_cbranch_scc1 L_b_215_n
s_waitcnt vmcnt(3)
L_b_215_n:
s_waitcnt vmcnt(4)
L_b_215:
s_waitcnt vmcnt(5)
buffer_load_dwordx4 v[136:139], v2, s[12:15], s29 offen offset:0 nt
s_cmp_lg_u32 s64, 1
s_cbranch_scc1 L_c_216
v_mov_b32 v6, 1
s_mov_b64 exec, 1
ds_add_rtn_u32 v253, v7, v6 offset:80
s_mov_b64 exec, -1
L_c_216:
s_waitcnt lgkmcnt(0)
ds_read_b128 v[28:31], v4 offset:1536
v_and_b32 v20, v32, v8
v_and_b32 v21, v32, v9
v_and_b32 v22, v32, v10
v_and_b32 v23, v32, v11
s_nop 1
v_mfma_f32_16x16x32_bf16 v[12:15], v[20:23], v[104:107], v[12:15]
s_cmpk_gt_u32 s61, 227
s_cbranch_scc1 L_b_217
s_cmpk_le_u32 s60, 227
s_cbranch_scc1 L_b_217_n
s_waitcnt vmcnt(3)
L_b_217_n:
s_waitcnt vmcnt(4)
L_b_217:
s_waitcnt vmcnt(5)
buffer_load_dwordx4 v[140:143], v2, s[12:15], s29 offen offset:2048 nt
s_add_u32 s29, s29, 0x7f000
s_bitset0_b32 s29, 24
v_and_b32 v24, v33, v8
v_and_b32 v25, v33, v9
v_and_b32 v26, v33, v10
v_and_b32 v27, v33, v11
s_nop 1
v_mfma_f32_16x16x32_bf16 v[12:15], v[24:27], v[108:111], v[12:15]
s_cmpk_gt_u32 s61, 228
s_cbranch_scc1 L_b_218
s_cmpk_le_u32 s60, 228
s_cbranch_scc1 L_b_218_n
s_waitcnt vmcnt(3)
L_b_218_n:
s_waitcnt vmcnt(4)
L_b_218:
s_waitcnt vmcnt(5)
buffer_load_dwordx4 v[144:147], v2, s[12:15], s29 offen offset:0 nt
s_cmp_lg_u32 s64, 0
s_cbranch_scc1 L_c_219
ds_read_b32 v254, v7 offset:144
L_c_219:
v_and_b32 v20, v34, v8
v_and_b32 v21, v34, v9
v_and_b32 v22, v34, v10
v_and_b32 v23, v34, v11
s_nop 1
v_mfma_f32_16x16x32_bf16 v[12:15], v[20:23], v[116:119], v[12:15]
s_cmpk_gt_u32 s61, 229
s_cbranch_scc1 L_b_220
s_cmpk_le_u32 s60, 229
s_cbranch_scc1 L_b_220_n
s_waitcnt vmcnt(3)
L_b_220_n:
s_waitcnt vmcnt(4)
L_b_220:
s_waitcnt vmcnt(5)
buffer_load_dwordx4 v[148:151], v2, s[12:15], s29 offen offset:2048 nt
s_add_u32 s29, s29, 0x1000
s_cmp_lg_u32 s64, 0
s_cbranch_scc1 L_c_221
s_waitcnt lgkmcnt(0)
v_readfirstlane_b32 s7, v253
v_readfirstlane_b32 s65, v254
s_mul_i32 s7, s7, 3
s_sub_u32 s7, s7, 4
s_add_u32 s7, s7, s65
s_add_u32 s61, s7, 230
s_sub_u32 s60, 230, s7
L_c_221:
v_and_b32 v24, v35, v8
v_and_b32 v25, v35, v9
v_and_b32 v26, v35, v10
v_and_b32 v27, v35, v11
s_nop 1
v_mfma_f32_16x16x32_bf16 v[12:15], v[24:27], v[120:123], v[12:15]
s_cmpk_gt_u32 s61, 230
s_cbranch_scc1 L_b_222
s_cmpk_le_u32 s60, 230
s_cbranch_scc1 L_b_222_n
s_waitcnt vmcnt(3)
L_b_222_n:
s_waitcnt vmcnt(4)
L_b_222:
s_waitcnt vmcnt(5)
buffer_load_dwordx4 v[156:159], v2, s[12:15], s29 offen offset:0 nt
s_waitcnt lgkmcnt(0)
ds_read_b128 v[32:35], v4 offset:1600
v_and_b32 v20, v28, v8
v_and_b32 v21, v28, v9
v_and_b32 v22, v28, v10
v_and_b32 v23, v28, v11
s_nop 1
v_mfma_f32_16x16x32_bf16 v[12:15], v[20:23], v[124:127], v[12:15]
s_cmpk_gt_u32 s61, 231
s_cbranch_scc1 L_b_223
s_cmpk_le_u32 s60, 231
s_cbranch_scc1 L_b_223_n
s_waitcnt vmcnt(3)
L_b_223_n:
s_waitcnt vmcnt(4)
L_b_223:
s_waitcnt vmcnt(5)
buffer_load_dwordx4 v[160:163], v2, s[12:15], s29 offen offset:2048 nt
s_add_u32 s29, s29, 0x7f000
s_bitset0_b32 s29, 24
v_and_b32 v24, v29, v8
v_and_b32 v25, v29, v9
v_and_b32 v26, v29, v10
v_and_b32 v27, v29, v11
s_nop 1
v_mfma_f32_16x16x32_bf16 v[12:15], v[24:27], v[128:131], v[12:15]
s_cmpk_gt_u32 s61, 232
s_cbranch_scc1 L_b_224
s_cmpk_le_u32 s60, 232
s_cbranch_scc1 L_b_224_n
s_waitcnt vmcnt(3)
L_b_224_n:
s_waitcnt vmcnt(4)
L_b_224:
s_waitcnt vmcnt(5)
buffer_load_dwordx4 v[164:167], v2, s[12:15], s29 offen offset:0 nt
v_mov_b32 v6, 232
s_mov_b64 exec, 1
ds_max_u32 v7, v6 offset:12
s_mov_b64 exec, -1
s_cmp_lg_u32 s64, 0
s_cbranch_scc1 L_c_225
ds_read_b32 v254, v7 offset:144
L_c_225:
s_cmp_lg_u32 s64, 1
s_cbranch_scc1 L_c_226
ds_read_b32 v254, v7 offset:144
L_c_226:
v_and_b32 v20, v30, v8
v_and_b32 v21, v30, v9
v_and_b32 v22, v30, v10
v_and_b32 v23, v30, v11
s_nop 1
v_mfma_f32_16x16x32_bf16 v[12:15], v[20:23], v[136:139], v[12:15]
s_cmpk_gt_u32 s61, 233
s_cbranch_scc1 L_b_227
s_cmpk_le_u32 s60, 233
s_cbranch_scc1 L_b_227_n
s_waitcnt vmcnt(3)
L_b_227_n:
s_waitcnt vmcnt(4)
L_b_227:
s_waitcnt vmcnt(5)
buffer_load_dwordx4 v[168:171], v2, s[12:15], s29 offen offset:2048 nt
s_add_u32 s29, s29, 0x1000
s_cmp_lg_u32 s64, 0
s_cbranch_scc1 L_c_228
s_waitcnt lgkmcnt(0)
v_readfirstlane_b32 s7, v253
v_readfirstlane_b32 s65, v254
s_mul_i32 s7, s7, 3
s_sub_u32 s7, s7, 4
s_add_u32 s7, s7, s65
s_add_u32 s61, s7, 230
s_sub_u32 s60, 230, s7
L_c_228:
s_cmp_lg_u32 s64, 1
s_cbranch_scc1 L_c_229
s_waitcnt lgkmcnt(0)
v_readfirstlane_b32 s7, v253
v_readfirstlane_b32 s65, v254
s_mul_i32 s7, s7, 3
s_sub_u32 s7, s7, 4
s_add_u32 s7, s7, s65
s_add_u32 s61, s7, 234
s_sub_u32 s60, 234, s7
L_c_229:
v_and_b32 v24, v31, v8
v_and_b32 v25, v31, v9
v_and_b32 v26, v31, v10
v_and_b32 v27, v31, v11
s_nop 1
v_mfma_f32_16x16x32_bf16 v[12:15], v[24:27], v[140:143], v[12:15]
s_cmpk_gt_u32 s61, 234
s_cbranch_scc1 L_b_230
s_cmpk_le_u32 s60, 234
s_cbranch_scc1 L_b_230_n
s_waitcnt vmcnt(3)
L_b_230_n:
s_waitcnt vmcnt(4)
L_b_230:
s_waitcnt vmcnt(5)
buffer_load_dwordx4 v[176:179], v2, s[12:15], s29 offen offset:0 nt
s_waitcnt lgkmcnt(0)
ds_read_b128 v[28:31], v4 offset:1664
v_and_b32 v20, v32, v8
v_and_b32 v21, v32, v9
v_and_b32 v22, v32, v10
v_and_b32 v23, v32, v11
s_nop 1
v_mfma_f32_16x16x32_bf16 v[12:15], v[20:23], v[144:147], v[12:15]
s_cmpk_gt_u32 s61, 235
s_cbranch_scc1 L_b_231
s_cmpk_le_u32 s60, 235
s_cbranch_scc1 L_b_231_n
s_waitcnt vmcnt(3)
L_b_231_n:
s_waitcnt vmcnt(4)
L_b_231:
s_waitcnt vmcnt(5)
buffer_load_dwordx4 v[180:183], v2, s[12:15], s29 offen offset:2048 nt
s_add_u32 s29, s29, 0x7f000
s_bitset0_b32 s29, 24
v_and_b32 v24, v33, v8
v_and_b32 v25, v33, v9
v_and_b32 v26, v33, v10
v_and_b32 v27, v33, v11
s_nop 1
v_mfma_f32_16x16x32_bf16 v[12:15], v[24:27], v[148:151], v[12:15]
s_cmpk_gt_u32 s61, 236
s_cbranch_scc1 L_b_232
s_cmpk_le_u32 s60, 236
s_cbranch_scc1 L_b_232_n
s_waitcnt vmcnt(3)
L_b_232_n:
s_waitcnt vmcnt(4)
L_b_232:
s_waitcnt vmcnt(5)
buffer_load_dwordx4 v[184:187], v2, s[12:15], s29 offen offset:0 nt
s_cmp_lg_u32 s64, 1
s_cbranch_scc1 L_c_233
ds_read_b32 v254, v7 offset:144
L_c_233:
v_and_b32 v20, v34, v8
v_and_b32 v21, v34, v9
v_and_b32 v22, v34, v10
v_and_b32 v23, v34, v11
s_nop 1
v_mfma_f32_16x16x32_bf16 v[12:15], v[20:23], v[156:159], v[12:15]
s_cmpk_gt_u32 s61, 237
s_cbranch_scc1 L_b_234
s_cmpk_le_u32 s60, 237
s_cbranch_scc1 L_b_234_n
s_waitcnt vmcnt(3)
L_b_234_n:
s_waitcnt vmcnt(4)
L_b_234:
s_waitcnt vmcnt(5)
buffer_load_dwordx4 v[188:191], v2, s[12:15], s29 offen offset:2048 nt
s_add_u32 s29, s29, 0x1000
s_cmp_lg_u32 s64, 1
s_cbranch_scc1 L_c_235
s_waitcnt lgkmcnt(0)
v_readfirstlane_b32 s7, v253
v_readfirstlane_b32 s65, v254
s_mul_i32 s7, s7, 3
s_sub_u32 s7, s7, 4
s_add_u32 s7, s7, s65
s_add_u32 s61, s7, 234
s_sub_u32 s60, 234, s7
L_c_235:
v_and_b32 v24, v35, v8
v_and_b32 v25, v35, v9
v_and_b32 v26, v35, v10
v_and_b32 v27, v35, v11
s_nop 1
v_mfma_f32_16x16x32_bf16 v[12:15], v[24:27], v[160:163], v[12:15]
s_cmpk_gt_u32 s61, 238
s_cbranch_scc1 L_b_236
s_cmpk_le_u32 s60, 238
s_cbranch_scc1 L_b_236_n
s_waitcnt vmcnt(3)
L_b_236_n:
s_waitcnt vmcnt(4)
L_b_236:
s_waitcnt vmcnt(5)
buffer_load_dwordx4 v[196:199], v2, s[12:15], s29 offen offset:0 nt
s_cmp_lg_u32 s64, 0
s_cbranch_scc1 L_c_237
v_mov_b32 v6, 1
s_mov_b64 exec, 1
ds_add_rtn_u32 v253, v7, v6 offset:84
s_mov_b64 exec, -1
L_c_237:
s_waitcnt lgkmcnt(0)
ds_read_b128 v[32:35], v4 offset:1728
v_and_b32 v20, v28, v8
v_and_b32 v21, v28, v9
v_and_b32 v22, v28, v10
v_and_b32 v23, v28, v11
s_nop 1
v_mfma_f32_16x16x32_bf16 v[12:15], v[20:23], v[164:167], v[12:15]
s_cmpk_gt_u32 s61, 239
s_cbranch_scc1 L_b_238
s_cmpk_le_u32 s60, 239
s_cbranch_scc1 L_b_238_n
s_waitcnt vmcnt(3)
L_b_238_n:
s_waitcnt vmcnt(4)
L_b_238:
s_waitcnt vmcnt(5)
buffer_load_dwordx4 v[200:203], v2, s[12:15], s29 offen offset:2048 nt
s_add_u32 s29, s29, 0x7f000
s_bitset0_b32 s29, 24
v_and_b32 v24, v29, v8
v_and_b32 v25, v29, v9
v_and_b32 v26, v29, v10
v_and_b32 v27, v29, v11
s_nop 1
v_mfma_f32_16x16x32_bf16 v[12:15], v[24:27], v[168:171], v[12:15]
s_cmpk_gt_u32 s61, 240
s_cbranch_scc1 L_b_239
s_cmpk_le_u32 s60, 240
s_cbranch_scc1 L_b_239_n
s_waitcnt vmcnt(3)
L_b_239_n:
s_waitcnt vmcnt(4)
L_b_239:
s_waitcnt vmcnt(5)
buffer_load_dwordx4 v[204:207], v2, s[12:15], s29 offen offset:0 nt
v_and_b32 v20, v30, v8
v_and_b32 v21, v30, v9
v_and_b32 v22, v30, v10
v_and_b32 v23, v30, v11
s_nop 1
v_mfma_f32_16x16x32_bf16 v[12:15], v[20:23], v[176:179], v[12:15]
s_cmpk_gt_u32 s61, 241
s_cbranch_scc1 L_b_240
s_cmpk_le_u32 s60, 241
s_cbranch_scc1 L_b_240_n
s_waitcnt vmcnt(3)
L_b_240_n:
s_waitcnt vmcnt(4)
L_b_240:
s_waitcnt vmcnt(5)
buffer_load_dwordx4 v[208:211], v2, s[12:15], s29 offen offset:2048 nt
s_add_u32 s29, s29, 0x1000
v_and_b32 v24, v31, v8
v_and_b32 v25, v31, v9
v_and_b32 v26, v31, v10
v_and_b32 v27, v31, v11
s_nop 1
v_mfma_f32_16x16x32_bf16 v[12:15], v[24:27], v[180:183], v[12:15]
s_cmpk_gt_u32 s61, 242
s_cbranch_scc1 L_b_241
s_cmpk_le_u32 s60, 242
s_cbranch_scc1 L_b_241_n
s_waitcnt vmcnt(3)
L_b_241_n:
s_waitcnt vmcnt(4)
L_b_241:
s_waitcnt vmcnt(5)
buffer_load_dwordx4 v[216:219], v2, s[12:15], s29 offen offset:0 nt
s_cmp_lg_u32 s64, 1
s_cbranch_scc1 L_c_242
v_mov_b32 v6, 1
s_mov_b64 exec, 1
ds_add_rtn_u32 v253, v7, v6 offset:84
s_mov_b64 exec, -1
L_c_242:
s_waitcnt lgkmcnt(0)
ds_read_b128 v[28:31], v4 offset:1792
v_and_b32 v20, v32, v8
v_and_b32 v21, v32, v9
v_and_b32 v22, v32, v10
v_and_b32 v23, v32, v11
s_nop 1
v_mfma_f32_16x16x32_bf16 v[12:15], v[20:23], v[184:187], v[12:15]
s_cmpk_gt_u32 s61, 243
s_cbranch_scc1 L_b_243
s_cmpk_le_u32 s60, 243
s_cbranch_scc1 L_b_243_n
s_waitcnt vmcnt(3)
L_b_243_n:
s_waitcnt vmcnt(4)
L_b_243:
s_waitcnt vmcnt(5)
buffer_load_dwordx4 v[220:223], v2, s[12:15], s29 offen offset:2048 nt
s_add_u32 s29, s29, 0x7f000
s_bitset0_b32 s29, 24
v_and_b32 v24, v33, v8
v_and_b32 v25, v33, v9
v_and_b32 v26, v33, v10
v_and_b32 v27, v33, v11
s_nop 1
v_mfma_f32_16x16x32_bf16 v[12:15], v[24:27], v[188:191], v[12:15]
s_cmpk_gt_u32 s61, 244
s_cbranch_scc1 L_b_244
s_cmpk_le_u32 s60, 244
s_cbranch_scc1 L_b_244_n
s_waitcnt vmcnt(3)
L_b_244_n:
s_waitcnt vmcnt(4)
L_b_244:
s_waitcnt vmcnt(5)
buffer_load_dwordx4 v[36:39], v2, s[12:15], s29 offen offset:0 nt
s_cmp_lg_u32 s64, 0
s_cbranch_scc1 L_c_245
ds_read_b32 v254, v7 offset:148
L_c_245:
v_and_b32 v20, v34, v8
v_and_b32 v21, v34, v9
v_and_b32 v22, v34, v10
v_and_b32 v23, v34, v11
s_nop 1
v_mfma_f32_16x16x32_bf16 v[12:15], v[20:23], v[196:199], v[12:15]
s_cmpk_gt_u32 s61, 245
s_cbranch_scc1 L_b_246
s_cmpk_le_u32 s60, 245
s_cbranch_scc1 L_b_246_n
s_waitcnt vmcnt(3)
L_b_246_n:
s_waitcnt vmcnt(4)
L_b_246:
s_waitcnt vmcnt(5)
buffer_load_dwordx4 v[40:43], v2, s[12:15], s29 offen offset:2048 nt
s_add_u32 s29, s29, 0x1000
s_cmp_lg_u32 s64, 0
s_cbranch_scc1 L_c_247
s_waitcnt lgkmcnt(0)
v_readfirstlane_b32 s7, v253
v_readfirstlane_b32 s65, v254
s_mul_i32 s7, s7, 3
s_sub_u32 s7, s7, 4
s_add_u32 s7, s7, s65
s_add_u32 s61, s7, 246
s_sub_u32 s60, 246, s7
L_c_247:
v_and_b32 v24, v35, v8
v_and_b32 v25, v35, v9
v_and_b32 v26, v35, v10
v_and_b32 v27, v35, v11
s_nop 1
v_mfma_f32_16x16x32_bf16 v[12:15], v[24:27], v[200:203], v[12:15]
s_cmpk_gt_u32 s61, 246
s_cbranch_scc1 L_b_248
s_cmpk_le_u32 s60, 246
s_cbranch_scc1 L_b_248_n
s_waitcnt vmcnt(3)
L_b_248_n:
s_waitcnt vmcnt(4)
L_b_248:
s_waitcnt vmcnt(5)
buffer_load_dwordx4 v[44:47], v2, s[12:15], s29 offen offset:0 nt
s_waitcnt lgkmcnt(0)
ds_read_b128 v[32:35], v4 offset:1856
v_and_b32 v20, v28, v8
v_and_b32 v21, v28, v9
v_and_b32 v22, v28, v10
v_and_b32 v23, v28, v11
s_nop 1
v_mfma_f32_16x16x32_bf16 v[12:15], v[20:23], v[204:207], v[12:15]
s_cmpk_gt_u32 s61, 247
s_cbranch_scc1 L_b_249
s_cmpk_le_u32 s60, 247
s_cbranch_scc1 L_b_249_n
s_waitcnt vmcnt(3)
L_b_249_n:
s_waitcnt vmcnt(4)
L_b_249:
s_waitcnt vmcnt(5)
buffer_load_dwordx4 v[48:51], v2, s[12:15], s29 offen offset:2048 nt
s_add_u32 s29, s29, 0x7f000
s_bitset0_b32 s29, 24
v_and_b32 v24, v29, v8
v_and_b32 v25, v29, v9
v_and_b32 v26, v29, v10
v_and_b32 v27, v29, v11
s_nop 1
v_mfma_f32_16x16x32_bf16 v[12:15], v[24:27], v[208:211], v[12:15]
s_cmpk_gt_u32 s61, 248
s_cbranch_scc1 L_b_250
s_cmpk_le_u32 s60, 248
s_cbranch_scc1 L_b_250_n
s_waitcnt vmcnt(3)
L_b_250_n:
s_waitcnt vmcnt(4)
L_b_250:
s_waitcnt vmcnt(5)
buffer_load_dwordx4 v[52:55], v2, s[12:15], s29 offen offset:0 nt
s_cmp_lg_u32 s64, 0
s_cbranch_scc1 L_c_251
ds_read_b32 v254, v7 offset:148
L_c_251:
s_cmp_lg_u32 s64, 1
s_cbranch_scc1 L_c_252
ds_read_b32 v254, v7 offset:148
L_c_252:
v_and_b32 v20, v30, v8
v_and_b32 v21, v30, v9
v_and_b32 v22, v30, v10
v_and_b32 v23, v30, v11
s_nop 1
v_mfma_f32_16x16x32_bf16 v[12:15], v[20:23], v[216:219], v[12:15]
s_cmpk_gt_u32 s61, 249
s_cbranch_scc1 L_b_253
s_cmpk_le_u32 s60, 249
s_cbranch_scc1 L_b_253_n
s_waitcnt vmcnt(3)
L_b_253_n:
s_waitcnt vmcnt(4)
L_b_253:
s_waitcnt vmcnt(5)
buffer_load_dwordx4 v[56:59], v2, s[12:15], s29 offen offset:2048 nt
s_add_u32 s29, s29, 0x1000
s_cmp_lg_u32 s64, 0
s_cbranch_scc1 L_c_254
s_waitcnt lgkmcnt(0)
v_readfirstlane_b32 s7, v253
v_readfirstlane_b32 s65, v254
s_mul_i32 s7, s7, 3
s_sub_u32 s7, s7, 4
s_add_u32 s7, s7, s65
s_add_u32 s61, s7, 246
s_sub_u32 s60, 246, s7
L_c_254:
s_cmp_lg_u32 s64, 1
s_cbranch_scc1 L_c_255
s_waitcnt lgkmcnt(0)
v_readfirstlane_b32 s7, v253
v_readfirstlane_b32 s65, v254
s_mul_i32 s7, s7, 3
s_sub_u32 s7, s7, 4
s_add_u32 s7, s7, s65
s_add_u32 s61, s7, 250
s_sub_u32 s60, 250, s7
L_c_255:
v_and_b32 v24, v31, v8
v_and_b32 v25, v31, v9
v_and_b32 v26, v31, v10
v_and_b32 v27, v31, v11
s_nop 1
v_mfma_f32_16x16x32_bf16 v[12:15], v[24:27], v[220:223], v[12:15]
s_cmpk_gt_u32 s61, 250
s_cbranch_scc1 L_b_256
s_cmpk_le_u32 s60, 250
s_cbranch_scc1 L_b_256_n
s_waitcnt vmcnt(3)
L_b_256_n:
s_waitcnt vmcnt(4)
L_b_256:
s_waitcnt vmcnt(5)
buffer_load_dwordx4 v[60:63], v2, s[12:15], s29 offen offset:0 nt
s_waitcnt lgkmcnt(0)
ds_read_b128 v[28:31], v4 offset:1920
v_and_b32 v20, v32, v8
v_and_b32 v21, v32, v9
v_and_b32 v22, v32, v10
v_and_b32 v23, v32, v11
s_nop 1
v_mfma_f32_16x16x32_bf16 v[12:15], v[20:23], v[36:39], v[12:15]
s_cmpk_gt_u32 s61, 251
s_cbranch_scc1 L_b_257
s_cmpk_le_u32 s60, 251
s_cbranch_scc1 L_b_257_n
s_waitcnt vmcnt(3)
L_b_257_n:
s_waitcnt vmcnt(4)
L_b_257:
s_waitcnt vmcnt(5)
buffer_load_dwordx4 v[64:67], v2, s[12:15], s29 offen offset:2048 nt
s_add_u32 s29, s29, 0x7f000
s_bitset0_b32 s29, 24
v_and_b32 v24, v33, v8
v_and_b32 v25, v33, v9
v_and_b32 v26, v33, v10
v_and_b32 v27, v33, v11
s_nop 1
v_mfma_f32_16x16x32_bf16 v[12:15], v[24:27], v[40:43], v[12:15]
s_cmpk_gt_u32 s61, 252
s_cbranch_scc1 L_b_258
s_cmpk_le_u32 s60, 252
s_cbranch_scc1 L_b_258_n
s_waitcnt vmcnt(3)
L_b_258_n:
s_waitcnt vmcnt(4)
L_b_258:
s_waitcnt vmcnt(5)
buffer_load_dwordx4 v[68:71], v2, s[12:15], s29 offen offset:0 nt
s_cmp_lg_u32 s64, 1
s_cbranch_scc1 L_c_259
ds_read_b32 v254, v7 offset:148
L_c_259:
v_and_b32 v20, v34, v8
v_and_b32 v21, v34, v9
v_and_b32 v22, v34, v10
v_and_b32 v23, v34, v11
s_nop 1
v_mfma_f32_16x16x32_bf16 v[12:15], v[20:23], v[44:47], v[12:15]
s_cmpk_gt_u32 s61, 253
s_cbranch_scc1 L_b_260
s_cmpk_le_u32 s60, 253
s_cbranch_scc1 L_b_260_n
s_waitcnt vmcnt(3)
L_b_260_n:
s_waitcnt vmcnt(4)
L_b_260:
s_waitcnt vmcnt(5)
buffer_load_dwordx4 v[72:75], v2, s[12:15], s29 offen offset:2048 nt
s_add_u32 s29, s29, 0x1000
s_cmp_lg_u32 s64, 1
s_cbranch_scc1 L_c_261
s_waitcnt lgkmcnt(0)
v_readfirstlane_b32 s7, v253
v_readfirstlane_b32 s65, v254
s_mul_i32 s7, s7, 3
s_sub_u32 s7, s7, 4
s_add_u32 s7, s7, s65
s_add_u32 s61, s7, 250
s_sub_u32 s60, 250, s7
L_c_261:
v_and_b32 v24, v35, v8
v_and_b32 v25, v35, v9
v_and_b32 v26, v35, v10
v_and_b32 v27, v35, v11
s_nop 1
v_mfma_f32_16x16x32_bf16 v[12:15], v[24:27], v[48:51], v[12:15]
s_cmpk_gt_u32 s61, 254
s_cbranch_scc1 L_b_262
s_cmpk_le_u32 s60, 254
s_cbranch_scc1 L_b_262_n
s_waitcnt vmcnt(3)
L_b_262_n:
s_waitcnt vmcnt(4)
L_b_262:
s_waitcnt vmcnt(5)
buffer_load_dwordx4 v[76:79], v2, s[12:15], s29 offen offset:0 nt
s_waitcnt lgkmcnt(0)
ds_read_b128 v[32:35], v4 offset:1984
v_and_b32 v20, v28, v8
v_and_b32 v21, v28, v9
v_and_b32 v22, v28, v10
v_and_b32 v23, v28, v11
s_nop 1
v_mfma_f32_16x16x32_bf16 v[12:15], v[20:23], v[52:55], v[12:15]
s_cmpk_gt_u32 s61, 255
s_cbranch_scc1 L_b_263
s_cmpk_le_u32 s60, 255
s_cbranch_scc1 L_b_263_n
s_waitcnt vmcnt(3)
L_b_263_n:
s_waitcnt vmcnt(4)
L_b_263:
s_waitcnt vmcnt(5)
buffer_load_dwordx4 v[80:83], v2, s[12:15], s29 offen offset:2048 nt
v_mov_b32 v6, 1
s_mov_b64 exec, 1
ds_add_u32 v7, v6 offset:28
s_mov_b64 exec, -1
v_and_b32 v24, v29, v8
v_and_b32 v25, v29, v9
v_and_b32 v26, v29, v10
v_and_b32 v27, v29, v11
s_nop 1
v_mfma_f32_16x16x32_bf16 v[12:15], v[24:27], v[56:59], v[12:15]
v_and_b32 v20, v30, v8
v_and_b32 v21, v30, v9
v_and_b32 v22, v30, v10
v_and_b32 v23, v30, v11
s_waitcnt vmcnt(5)
s_nop 0
v_mfma_f32_16x16x32_bf16 v[12:15], v[20:23], v[60:63], v[12:15]
v_and_b32 v24, v31, v8
v_and_b32 v25, v31, v9
v_and_b32 v26, v31, v10
v_and_b32 v27, v31, v11
s_waitcnt vmcnt(4)
s_nop 0
v_mfma_f32_16x16x32_bf16 v[12:15], v[24:27], v[64:67], v[12:15]
s_waitcnt lgkmcnt(0)
v_and_b32 v20, v32, v8
v_and_b32 v21, v32, v9
v_and_b32 v22, v32, v10
v_and_b32 v23, v32, v11
s_waitcnt vmcnt(3)
s_nop 0
v_mfma_f32_16x16x32_bf16 v[12:15], v[20:23], v[68:71], v[12:15]
s_mov_b32 s30, 262144
L_w_264:
ds_read_b32 v5, v7 offset:44
s_waitcnt lgkmcnt(0)
v_readfirstlane_b32 s7, v5
s_cmp_ge_u32 s7, 1
s_cbranch_scc1 L_w_264_d
s_sleep 1
s_sub_u32 s30, s30, 1
s_cmp_lg_u32 s30, 0
s_cbranch_scc1 L_w_264
L_w_264_d:
v_and_b32 v24, v33, v8
v_and_b32 v25, v33, v9
v_and_b32 v26, v33, v10
v_and_b32 v27, v33, v11
s_waitcnt vmcnt(2)
s_nop 0
v_mfma_f32_16x16x32_bf16 v[12:15], v[24:27], v[72:75], v[12:15]
v_and_b32 v20, v34, v8
v_and_b32 v21, v34, v9
v_and_b32 v22, v34, v10
v_and_b32 v23, v34, v11
s_waitcnt vmcnt(1)
s_nop 0
v_mfma_f32_16x16x32_bf16 v[12:15], v[20:23], v[76:79], v[12:15]
v_and_b32 v24, v35, v8
v_and_b32 v25, v35, v9
v_and_b32 v26, v35, v10
v_and_b32 v27, v35, v11
s_waitcnt vmcnt(0)
s_nop 0
v_mfma_f32_16x16x32_bf16 v[12:15], v[24:27], v[80:83], v[12:15]
s_nop 7
ds_write_b128 v3, v[12:15]
s_mov_b64 exec, 1
ds_add_rtn_u32 v5, v16, v17 offset:32
s_mov_b64 exec, -1
ds_read_b128 v[40:43], v1
s_mov_b64 exec, 1
ds_add_u32 v7, v17 offset:20
s_mov_b64 exec, -1
s_waitcnt lgkmcnt(1)
v_readfirstlane_b32 s7, v5
v_pk_add_f32 v[12:13], v[12:13], v[40:41]
v_pk_add_f32 v[14:15], v[14:15], v[42:43]
s_cmp_lg_u32 s7, 1
s_cbranch_scc1 L_stream_end
s_cmp_eq_u32 s62, 2
s_cbranch_scc0 L_s_265_slow
buffer_store_dwordx4 v[12:15], v18, s[16:19], s28 offen
s_branch L_s_265_done
L_s_265_slow:
buffer_store_dwordx4 v[12:15], v18, s[16:19], s28 offen sc1
L_s_265_done:
v_mov_b32 v6, 1
s_mov_b64 exec, 1
ds_add_u32 v7, v6 offset:48
s_mov_b64 exec, -1
L_stream_end:
s_cmp_eq_u32 s68, 1
s_cbranch_scc1 L_D
s_endpgm
.p2align 6
L_helper:
s_mov_b32 s16, s58
s_mov_b32 s17, s59
s_mov_b32 s18, 957440
s_mov_b32 s19, 0x20000
s_load_dword s31, s[58:59], 0
s_getreg_b32 s24, hwreg(HW_REG_XCC_ID, 0, 4)
s_sub_u32 s60, s3, 4
s_mul_i32 s7, s60, 112
v_lshrrev_b32 v1, 3, v0
v_and_b32 v2, 7, v0
v_mul_u32_u24 v13, 14, v1
v_add_u32 v13, s7, v13
v_lshl_add_u32 v12, v2, 1, v13
v_cmp_eq_u32 vcc, 7, v2
v_lshlrev_b32 v14, 1, v12
v_lshlrev_b32 v15, 2, v12
v_mov_b32 v3, 1073741824
v_cndmask_b32 v14, v14, v3, vcc
v_cndmask_b32 v15, v15, v3, vcc
s_sub_u32 s62, 255, s2
s_cmp_ge_u32 s62, 106
s_cbranch_scc1 L_noP
s_cmp_ge_u32 s62, 78
s_cbranch_scc1 L_P3
s_cmp_ge_u32 s62, 14
s_cbranch_scc1 L_P2
v_lshrrev_b32 v5, 4, v0
v_mul_u32_u24 v5, 1792, v5
v_and_b32 v6, 15, v0
v_lshl_add_u32 v5, v6, 4, v5
v_lshrrev_b32 v6, 1, v0
v_lshlrev_b32 v6, 8, v6
v_cmp_lt_u32 vcc, 63, v0
s_nop 1
v_cndmask_b32 v6, v6, v3, vcc
v_and_b32 v40, 1, v0
v_lshl_add_u32 v6, v40, 4, v6
s_mul_i32 s28, s60, 7168
s_lshl_b32 s7, s62, 8
s_add_u32 s28, s28, s7
s_add_u32 s28, s28, 696320
s_lshl_b32 s29, s60, 13
s_add_u32 s29, s29, 98304
s_cmp_ge_u32 s62, 8
s_cbranch_scc1 L_noclr
s_cmp_lt_u32 s62, 7
s_cselect_b32 s28, s28, s29
s_cselect_b32 s7, -1, 0
s_cselect_b64 vcc, -1, 0
v_mov_b32 v40, s7
v_mov_b32 v41, s7
v_mov_b32 v42, s7
v_mov_b32 v43, s7
v_cndmask_b32 v5, v6, v5, vcc
buffer_store_dwordx4 v[40:43], v5, s[16:19], s28 offen sc1
L_noclr:
s_mov_b32 s8, s52
s_mov_b32 s9, s53
s_mov_b32 s10, 2408448
s_mov_b32 s11, 0x20000
s_mov_b32 s12, s50
s_mov_b32 s13, s51
s_mov_b32 s14, 896
s_mov_b32 s15, 0x20000
buffer_load_dword v52, v14, s[12:15], 0 offen nt
v_mul_u32_u24 v53, 5376, v13
v_lshl_add_u32 v53, v2, 4, v53
s_lshl_b32 s28, s62, 7
buffer_load_dwordx4 v[64:67], v53, s[8:11], s28 offen nt
s_add_u32 s28, s28, 5376
buffer_load_dwordx4 v[68:71], v53, s[8:11], s28 offen nt
s_add_u32 s28, s28, 5376
buffer_load_dwordx4 v[72:75], v53, s[8:11], s28 offen nt
s_add_u32 s28, s28, 5376
buffer_load_dwordx4 v[76:79], v53, s[8:11], s28 offen nt
s_add_u32 s28, s28, 5376
buffer_load_dwordx4 v[80:83], v53, s[8:11], s28 offen nt
s_add_u32 s28, s28, 5376
s_lshl_b32 s63, s62, 8
s_add_u32 s63, s63, 4096
s_lshl_b32 s7, s60, 9
s_add_u32 s7, s7, 2048
v_lshl_add_u32 v16, v0, 3, s7
v_lshl_add_u32 v17, v1, 6, s7
s_lshl_b32 s7, s60, 10
s_add_u32 s7, s7, 4096
v_lshl_add_u32 v18, v0, 4, s7
v_bfe_u32 v5, v0, 2, 3
v_bfe_u32 v6, v0, 1, 1
v_lshl_add_u32 v5, v6, 4, v5
v_and_b32 v6, 1, v0
v_lshlrev_b32 v6, 3, v6
v_lshl_add_u32 v19, v5, 4, v6
v_lshlrev_b32 v4, 3, v0
v_cmp_lt_u32 vcc, 31, v0
s_nop 1
v_cndmask_b32 v4, v4, v3, vcc
v_and_b32 v6, 1, v0
v_lshlrev_b32 v6, 4, v6
v_mov_b32 v5, 0xffff
v_lshlrev_b32 v5, v6, v5
v_bfe_u32 v6, v0, 1, 2
v_cmp_eq_u32 vcc, 0, v6
s_nop 1
v_cndmask_b32 v8, 0, v5, vcc
v_cmp_eq_u32 vcc, 1, v6
s_nop 1
v_cndmask_b32 v9, 0, v5, vcc
v_cmp_eq_u32 vcc, 2, v6
s_nop 1
v_cndmask_b32 v10, 0, v5, vcc
v_cmp_eq_u32 vcc, 3, v6
s_nop 1
v_cndmask_b32 v11, 0, v5, vcc
s_waitcnt lgkmcnt(0)
s_mul_i32 s31, s31, 1664525
s_add_u32 s31, s31, 1013904223
s_xor_b32 s24, s24, s31
v_and_b32 v63, 31, v0
v_lshlrev_b32 v63, 2, v63
s_lshl_b32 s27, s4, 7
s_add_u32 s27, s27, 32768
s_cmp_lg_u32 s60, 0
s_cbranch_scc1 L_i_266
s_lshl_b32 s7, s5, 2
v_mov_b32 v5, s7
v_mov_b32 v6, s24
s_mov_b64 exec, 1
buffer_store_dword v6, v5, s[16:19], s27 offen
s_mov_b64 exec, -1
L_i_266:
s_waitcnt vmcnt(5)
v_lshlrev_b32 v54, 16, v52
v_and_b32 v55, 0xffff0000, v52
v_mul_f32 v56, 3216550459, v54
v_mul_f32 v57, 3216550459, v55
v_exp_f32 v56, v56
v_exp_f32 v57, v57
v_add_f32 v56, 1.0, v56
v_add_f32 v57, 1.0, v57
v_rcp_f32 v56, v56
v_rcp_f32 v57, v57
v_mul_f32 v54, v54, v56
v_mul_f32 v55, v55, v57
s_waitcnt vmcnt(4)
buffer_load_dwordx4 v[84:87], v53, s[8:11], s28 offen nt
s_add_u32 s28, s28, 5376
s_waitcnt vmcnt(4)
buffer_load_dwordx4 v[88:91], v53, s[8:11], s28 offen nt
s_add_u32 s28, s28, 5376
s_waitcnt vmcnt(4)
buffer_load_dwordx4 v[92:95], v53, s[8:11], s28 offen nt
s_add_u32 s28, s28, 5376
s_waitcnt vmcnt(4)
buffer_load_dwordx4 v[96:99], v53, s[8:11], s28 offen nt
s_add_u32 s28, s28, 5376
s_waitcnt vmcnt(4)
buffer_load_dwordx4 v[100:103], v53, s[8:11], s28 offen nt
s_add_u32 s28, s28, 5376
s_waitcnt vmcnt(4)
buffer_load_dwordx4 v[104:107], v53, s[8:11], s28 offen nt
s_add_u32 s28, s28, 5376
s_waitcnt vmcnt(4)
buffer_load_dwordx4 v[108:111], v53, s[8:11], s28 offen nt
s_add_u32 s28, s28, 5376
s_waitcnt vmcnt(4)
buffer_load_dwordx4 v[112:115], v53, s[8:11], s28 offen nt
s_add_u32 s28, s28, 5376
s_waitcnt vmcnt(4)
buffer_load_dwordx4 v[116:119], v53, s[8:11], s28 offen nt
s_mov_b32 s25, 1
v_lshlrev_b32 v62, 6, v0
v_cmp_gt_u32 vcc, 16, v0
s_nop 1
v_cndmask_b32 v62, v3, v62, vcc
s_lshl_b32 s26, s62, 2
s_add_u32 s26, s26, 34816
s_branch L_Pgemv
L_P3:
s_sub_u32 s62, s62, 64
s_mov_b32 s8, s52
s_mov_b32 s9, s53
s_mov_b32 s10, 2408448
s_mov_b32 s11, 0x20000
s_mov_b32 s12, s50
s_mov_b32 s13, s51
s_mov_b32 s14, 896
s_mov_b32 s15, 0x20000
buffer_load_dword v52, v14, s[12:15], 0 offen nt
v_mul_u32_u24 v53, 5376, v13
v_lshl_add_u32 v53, v2, 4, v53
s_lshl_b32 s28, s62, 7
buffer_load_dwordx4 v[64:67], v53, s[8:11], s28 offen nt
s_add_u32 s28, s28, 5376
buffer_load_dwordx4 v[68:71], v53, s[8:11], s28 offen nt
s_add_u32 s28, s28, 5376
s_lshl_b32 s63, s62, 8
s_add_u32 s63, s63, 4096
s_lshl_b32 s7, s60, 9
s_add_u32 s7, s7, 2048
v_lshl_add_u32 v16, v0, 3, s7
v_lshl_add_u32 v17, v1, 6, s7
s_lshl_b32 s7, s60, 10
s_add_u32 s7, s7, 4096
v_lshl_add_u32 v18, v0, 4, s7
v_bfe_u32 v5, v0, 2, 3
v_bfe_u32 v6, v0, 1, 1
v_lshl_add_u32 v5, v6, 4, v5
v_and_b32 v6, 1, v0
v_lshlrev_b32 v6, 3, v6
v_lshl_add_u32 v19, v5, 4, v6
v_lshlrev_b32 v4, 3, v0
v_cmp_lt_u32 vcc, 31, v0
s_nop 1
v_cndmask_b32 v4, v4, v3, vcc
v_and_b32 v6, 1, v0
v_lshlrev_b32 v6, 4, v6
v_mov_b32 v5, 0xffff
v_lshlrev_b32 v5, v6, v5
v_bfe_u32 v6, v0, 1, 2
v_cmp_eq_u32 vcc, 0, v6
s_nop 1
v_cndmask_b32 v8, 0, v5, vcc
v_cmp_eq_u32 vcc, 1, v6
s_nop 1
v_cndmask_b32 v9, 0, v5, vcc
v_cmp_eq_u32 vcc, 2, v6
s_nop 1
v_cndmask_b32 v10, 0, v5, vcc
v_cmp_eq_u32 vcc, 3, v6
s_nop 1
v_cndmask_b32 v11, 0, v5, vcc
s_waitcnt lgkmcnt(0)
s_mul_i32 s31, s31, 1664525
s_add_u32 s31, s31, 1013904223
s_xor_b32 s24, s24, s31
v_and_b32 v63, 31, v0
v_lshlrev_b32 v63, 2, v63
s_lshl_b32 s27, s4, 7
s_add_u32 s27, s27, 32768
s_cmp_lg_u32 s60, 0
s_cbranch_scc1 L_i_267
s_lshl_b32 s7, s5, 2
v_mov_b32 v5, s7
v_mov_b32 v6, s24
s_mov_b64 exec, 1
buffer_store_dword v6, v5, s[16:19], s27 offen
s_mov_b64 exec, -1
L_i_267:
s_waitcnt vmcnt(2)
v_lshlrev_b32 v54, 16, v52
v_and_b32 v55, 0xffff0000, v52
v_mul_f32 v56, 3216550459, v54
v_mul_f32 v57, 3216550459, v55
v_exp_f32 v56, v56
v_exp_f32 v57, v57
v_add_f32 v56, 1.0, v56
v_add_f32 v57, 1.0, v57
v_rcp_f32 v56, v56
v_rcp_f32 v57, v57
v_mul_f32 v54, v54, v56
v_mul_f32 v55, v55, v57
s_waitcnt vmcnt(1)
buffer_load_dwordx4 v[72:75], v53, s[8:11], s28 offen nt
s_add_u32 s28, s28, 5376
s_waitcnt vmcnt(1)
buffer_load_dwordx4 v[76:79], v53, s[8:11], s28 offen nt
s_add_u32 s28, s28, 5376
s_waitcnt vmcnt(1)
buffer_load_dwordx4 v[80:83], v53, s[8:11], s28 offen nt
s_add_u32 s28, s28, 5376
s_waitcnt vmcnt(1)
buffer_load_dwordx4 v[84:87], v53, s[8:11], s28 offen nt
s_add_u32 s28, s28, 5376
s_waitcnt vmcnt(1)
buffer_load_dwordx4 v[88:91], v53, s[8:11], s28 offen nt
s_add_u32 s28, s28, 5376
s_waitcnt vmcnt(1)
buffer_load_dwordx4 v[92:95], v53, s[8:11], s28 offen nt
s_add_u32 s28, s28, 5376
s_waitcnt vmcnt(1)
buffer_load_dwordx4 v[96:99], v53, s[8:11], s28 offen nt
s_add_u32 s28, s28, 5376
s_waitcnt vmcnt(1)
buffer_load_dwordx4 v[100:103], v53, s[8:11], s28 offen nt
s_add_u32 s28, s28, 5376
s_waitcnt vmcnt(1)
buffer_load_dwordx4 v[104:107], v53, s[8:11], s28 offen nt
s_add_u32 s28, s28, 5376
s_waitcnt vmcnt(1)
buffer_load_dwordx4 v[108:111], v53, s[8:11], s28 offen nt
s_add_u32 s28, s28, 5376
s_waitcnt vmcnt(1)
buffer_load_dwordx4 v[112:115], v53, s[8:11], s28 offen nt
s_add_u32 s28, s28, 5376
s_waitcnt vmcnt(1)
buffer_load_dwordx4 v[116:119], v53, s[8:11], s28 offen nt
s_mov_b32 s25, 1
v_mov_b32 v62, v3
s_mov_b32 s26, 0
s_branch L_Pgemv
L_P2:
s_sub_u32 s62, s62, 14
s_and_b32 s26, s62, 15
s_lshl_b32 s26, s26, 6
s_add_u32 s26, s26, 34816
s_lshr_b32 s62, s62, 3
s_lshl_b32 s7, s4, 3
s_add_u32 s62, s62, s7
s_mov_b32 s8, s38
s_mov_b32 s9, s39
s_mov_b32 s10, 3670016
s_mov_b32 s11, 0x20000
s_mov_b32 s12, s32
s_mov_b32 s13, s33
s_mov_b32 s14, 896
s_mov_b32 s15, 0x20000
v_lshlrev_b32 v5, 4, v0
buffer_load_dwordx4 v[20:23], v5, s[12:15], 0 offen nt
buffer_load_dword v52, v14, s[12:15], 0 offen nt
v_lshlrev_b32 v53, 13, v13
v_lshl_add_u32 v53, v2, 4, v53
s_lshl_b32 s28, s62, 7
buffer_load_dwordx4 v[64:67], v53, s[8:11], s28 offen nt
s_add_u32 s28, s28, 8192
buffer_load_dwordx4 v[68:71], v53, s[8:11], s28 offen nt
s_add_u32 s28, s28, 8192
buffer_load_dwordx4 v[72:75], v53, s[8:11], s28 offen nt
s_add_u32 s28, s28, 8192
s_lshl_b32 s63, s62, 8
s_add_u32 s63, s63, 16384
s_lshl_b32 s7, s60, 9
s_add_u32 s7, s7, 2048
v_lshl_add_u32 v16, v0, 3, s7
v_lshl_add_u32 v17, v1, 6, s7
s_lshl_b32 s7, s60, 10
s_add_u32 s7, s7, 4096
v_lshl_add_u32 v18, v0, 4, s7
v_bfe_u32 v5, v0, 2, 3
v_bfe_u32 v6, v0, 1, 1
v_lshl_add_u32 v5, v6, 4, v5
v_and_b32 v6, 1, v0
v_lshlrev_b32 v6, 3, v6
v_lshl_add_u32 v19, v5, 4, v6
v_lshlrev_b32 v4, 3, v0
v_cmp_lt_u32 vcc, 31, v0
s_nop 1
v_cndmask_b32 v4, v4, v3, vcc
v_and_b32 v6, 1, v0
v_lshlrev_b32 v6, 4, v6
v_mov_b32 v5, 0xffff
v_lshlrev_b32 v5, v6, v5
v_bfe_u32 v6, v0, 1, 2
v_cmp_eq_u32 vcc, 0, v6
s_nop 1
v_cndmask_b32 v8, 0, v5, vcc
v_cmp_eq_u32 vcc, 1, v6
s_nop 1
v_cndmask_b32 v9, 0, v5, vcc
v_cmp_eq_u32 vcc, 2, v6
s_nop 1
v_cndmask_b32 v10, 0, v5, vcc
v_cmp_eq_u32 vcc, 3, v6
s_nop 1
v_cndmask_b32 v11, 0, v5, vcc
s_waitcnt lgkmcnt(0)
s_mul_i32 s31, s31, 1664525
s_add_u32 s31, s31, 1013904223
s_xor_b32 s24, s24, s31
v_and_b32 v63, 31, v0
v_lshlrev_b32 v63, 2, v63
s_lshl_b32 s27, s4, 7
s_add_u32 s27, s27, 32768
s_cmp_lg_u32 s60, 0
s_cbranch_scc1 L_i_268
s_lshl_b32 s7, s5, 2
v_mov_b32 v5, s7
v_mov_b32 v6, s24
s_mov_b64 exec, 1
buffer_store_dword v6, v5, s[16:19], s27 offen
s_mov_b64 exec, -1
L_i_268:
s_waitcnt vmcnt(2)
buffer_load_dwordx4 v[76:79], v53, s[8:11], s28 offen nt
s_add_u32 s28, s28, 8192
s_waitcnt vmcnt(2)
buffer_load_dwordx4 v[80:83], v53, s[8:11], s28 offen nt
s_add_u32 s28, s28, 8192
s_waitcnt vmcnt(2)
buffer_load_dwordx4 v[84:87], v53, s[8:11], s28 offen nt
s_add_u32 s28, s28, 8192
v_lshlrev_b32 v24, 16, v20
v_and_b32 v25, 0xffff0000, v20
v_lshlrev_b32 v26, 16, v21
v_and_b32 v27, 0xffff0000, v21
v_lshlrev_b32 v28, 16, v22
v_and_b32 v29, 0xffff0000, v22
v_lshlrev_b32 v30, 16, v23
v_and_b32 v31, 0xffff0000, v23
v_add_f32 v32, v24, v25
v_add_f32 v32, v32, v26
v_add_f32 v32, v32, v27
v_add_f32 v32, v32, v28
v_add_f32 v32, v32, v29
v_add_f32 v32, v32, v30
v_add_f32 v32, v32, v31
s_nop 1
v_add_f32_dpp v32, v32, v32 quad_perm:[1,0,3,2] row_mask:0xf bank_mask:0xf
s_nop 1
v_add_f32_dpp v32, v32, v32 quad_perm:[2,3,0,1] row_mask:0xf bank_mask:0xf
s_nop 1
v_add_f32_dpp v32, v32, v32 row_half_mirror row_mask:0xf bank_mask:0xf
s_nop 1
v_add_f32_dpp v32, v32, v32 row_mirror row_mask:0xf bank_mask:0xf
v_mov_b32 v33, v32
s_nop 1
v_permlane16_swap_b32 v32, v33
v_add_f32 v32, v32, v33
v_mov_b32 v33, v32
s_nop 1
v_permlane32_swap_b32 v32, v33
v_add_f32 v32, v32, v33
v_mul_f32 v32, 991054117, v32
v_sub_f32 v24, v24, v32
v_sub_f32 v25, v25, v32
v_sub_f32 v26, v26, v32
v_sub_f32 v27, v27, v32
v_sub_f32 v28, v28, v32
v_sub_f32 v29, v29, v32
v_sub_f32 v30, v30, v32
v_sub_f32 v31, v31, v32
v_mul_f32 v34, v24, v24
v_fmac_f32 v34, v25, v25
v_fmac_f32 v34, v26, v26
v_fmac_f32 v34, v27, v27
v_fmac_f32 v34, v28, v28
v_fmac_f32 v34, v29, v29
v_fmac_f32 v34, v30, v30
v_fmac_f32 v34, v31, v31
v_cmp_gt_u32 vcc, 56, v0
s_nop 1
v_cndmask_b32 v34, 0, v34, vcc
s_nop 1
v_add_f32_dpp v34, v34, v34 quad_perm:[1,0,3,2] row_mask:0xf bank_mask:0xf
s_nop 1
v_add_f32_dpp v34, v34, v34 quad_perm:[2,3,0,1] row_mask:0xf bank_mask:0xf
s_nop 1
v_add_f32_dpp v34, v34, v34 row_half_mirror row_mask:0xf bank_mask:0xf
s_nop 1
v_add_f32_dpp v34, v34, v34 row_mirror row_mask:0xf bank_mask:0xf
v_mov_b32 v33, v34
s_nop 1
v_permlane16_swap_b32 v34, v33
v_add_f32 v34, v34, v33
v_mov_b32 v33, v34
s_nop 1
v_permlane32_swap_b32 v34, v33
v_add_f32 v34, v34, v33
v_mul_f32 v34, 991054117, v34
v_lshlrev_b32 v54, 16, v52
v_and_b32 v55, 0xffff0000, v52
v_cvt_pk_bf16_f32 v33, v32, v34
v_lshlrev_b32 v32, 16, v33
v_and_b32 v34, 0xffff0000, v33
v_add_f32 v34, 925353388, v34
v_sub_f32 v54, v54, v32
v_sub_f32 v55, v55, v32
v_cvt_pk_bf16_f32 v34, v34, v34
v_lshlrev_b32 v34, 16, v34
v_sqrt_f32 v34, v34
v_cvt_pk_bf16_f32 v33, v54, v55
v_lshlrev_b32 v54, 16, v33
v_and_b32 v55, 0xffff0000, v33
v_cvt_pk_bf16_f32 v34, v34, v34
v_lshlrev_b32 v34, 16, v34
v_rcp_f32 v34, v34
s_nop 0
v_mul_f32 v54, v54, v34
v_mul_f32 v55, v55, v34
v_cvt_pk_bf16_f32 v33, v54, v55
v_lshlrev_b32 v54, 16, v33
v_and_b32 v55, 0xffff0000, v33
s_waitcnt vmcnt(2)
buffer_load_dwordx4 v[88:91], v53, s[8:11], s28 offen nt
s_add_u32 s28, s28, 8192
s_waitcnt vmcnt(2)
buffer_load_dwordx4 v[92:95], v53, s[8:11], s28 offen nt
s_add_u32 s28, s28, 8192
s_waitcnt vmcnt(2)
buffer_load_dwordx4 v[96:99], v53, s[8:11], s28 offen nt
s_add_u32 s28, s28, 8192
s_waitcnt vmcnt(2)
buffer_load_dwordx4 v[100:103], v53, s[8:11], s28 offen nt
s_add_u32 s28, s28, 8192
s_waitcnt vmcnt(2)
buffer_load_dwordx4 v[104:107], v53, s[8:11], s28 offen nt
s_add_u32 s28, s28, 8192
s_waitcnt vmcnt(2)
buffer_load_dwordx4 v[108:111], v53, s[8:11], s28 offen nt
s_add_u32 s28, s28, 8192
s_waitcnt vmcnt(2)
buffer_load_dwordx4 v[112:115], v53, s[8:11], s28 offen nt
s_add_u32 s28, s28, 8192
s_waitcnt vmcnt(2)
buffer_load_dwordx4 v[116:119], v53, s[8:11], s28 offen nt
s_mov_b32 s28, 4096
v_cmp_ne_u32 s[98:99], 7, v2
v_mov_b32 v62, v3
s_cmp_lg_u32 s60, 0
s_cbranch_scc1 L_mw
s_mov_b32 s30, 262144
L_hm_269:
s_load_dwordx16 s[76:91], s[58:59], s26 glc
s_mov_b32 s7, 0
s_waitcnt lgkmcnt(0)
s_cmp_eq_u32 s76, s31
s_addc_u32 s7, s7, 0
s_cmp_eq_u32 s77, s31
s_addc_u32 s7, s7, 0
s_cmp_eq_u32 s78, s31
s_addc_u32 s7, s7, 0
s_cmp_eq_u32 s79, s31
s_addc_u32 s7, s7, 0
s_cmp_eq_u32 s80, s31
s_addc_u32 s7, s7, 0
s_cmp_eq_u32 s81, s31
s_addc_u32 s7, s7, 0
s_cmp_eq_u32 s82, s31
s_addc_u32 s7, s7, 0
s_cmp_eq_u32 s83, s31
s_addc_u32 s7, s7, 0
s_cmp_eq_u32 s84, s31
s_addc_u32 s7, s7, 0
s_cmp_eq_u32 s85, s31
s_addc_u32 s7, s7, 0
s_cmp_eq_u32 s86, s31
s_addc_u32 s7, s7, 0
s_cmp_eq_u32 s87, s31
s_addc_u32 s7, s7, 0
s_cmp_eq_u32 s88, s31
s_addc_u32 s7, s7, 0
s_cmp_eq_u32 s89, s31
s_addc_u32 s7, s7, 0
s_cmp_ge_u32 s7, 14
s_cbranch_scc1 L_hm_269_d
s_sleep 4
s_sub_u32 s30, s30, 1
s_cmp_lg_u32 s30, 0
s_cbranch_scc1 L_hm_269
L_hm_269_d:
v_mov_b32 v6, 1
s_mov_b64 exec, 1
ds_write_b32 v7, v6 offset:40
s_mov_b64 exec, -1
L_mw:
s_mov_b32 s30, 262144
L_w_270:
ds_read_b32 v5, v7 offset:40
s_waitcnt lgkmcnt(0)
v_readfirstlane_b32 s7, v5
s_cmp_ge_u32 s7, 1
s_cbranch_scc1 L_w_270_d
s_sleep 1
s_sub_u32 s30, s30, 1
s_cmp_lg_u32 s30, 0
s_cbranch_scc1 L_w_270
L_w_270_d:
buffer_load_dword v35, v63, s[16:19], s27 offen sc1
s_mov_b32 s30, 262144
L_p_271:
buffer_load_dwordx2 v[56:57], v15, s[16:19], s28 offen sc1
buffer_load_dwordx2 v[58:59], v15, s[16:19], s28 offen offset:1792 sc1
s_waitcnt vmcnt(0)
v_cmp_ne_u32 vcc, s31, v57
v_cmp_ne_u32 s[100:101], s31, v59
s_or_b64 vcc, vcc, s[100:101]
s_and_b64 vcc, vcc, s[98:99]
s_cbranch_vccz L_p_271_d
s_sleep 2
s_sub_u32 s30, s30, 1
s_cmp_lg_u32 s30, 0
s_cbranch_scc1 L_p_271
L_p_271_d:
v_cmp_ne_u32 vcc, s24, v35
s_cmp_eq_u64 vcc, 0
s_cselect_b32 s25, 2, 1
v_lshlrev_b32 v60, 16, v58
v_and_b32 v61, 0xffff0000, v58
v_add_f32 v60, 1.0, v60
v_add_f32 v61, 1.0, v61
v_cvt_pk_bf16_f32 v33, v60, v61
v_lshlrev_b32 v60, 16, v33
v_and_b32 v61, 0xffff0000, v33
v_mul_f32 v54, v54, v60
v_mul_f32 v55, v55, v61
v_cvt_pk_bf16_f32 v33, v54, v55
v_lshlrev_b32 v54, 16, v33
v_and_b32 v55, 0xffff0000, v33
v_lshlrev_b32 v60, 16, v56
v_and_b32 v61, 0xffff0000, v56
v_add_f32 v54, v54, v60
v_add_f32 v55, v55, v61
L_Pgemv:
v_cvt_pk_bf16_f32 v54, v54, v54
v_cvt_pk_bf16_f32 v55, v55, v55
ds_write_b64 v16, v[54:55]
ds_read_b128 v[20:23], v17 offset:0
ds_read_b128 v[24:27], v17 offset:16
ds_read_b128 v[28:31], v17 offset:32
ds_read_b128 v[32:35], v17 offset:48
s_waitcnt lgkmcnt(0)
v_and_b32 v36, v20, v8
v_and_b32 v37, v20, v9
v_and_b32 v38, v20, v10
v_and_b32 v39, v20, v11
s_waitcnt vmcnt(13)
s_nop 0
v_mfma_f32_16x16x32_bf16 v[44:47], v[36:39], v[64:67], 0
v_and_b32 v40, v21, v8
v_and_b32 v41, v21, v9
v_and_b32 v42, v21, v10
v_and_b32 v43, v21, v11
s_waitcnt vmcnt(12)
s_nop 0
v_mfma_f32_16x16x32_bf16 v[44:47], v[40:43], v[68:71], v[44:47]
v_and_b32 v36, v22, v8
v_and_b32 v37, v22, v9
v_and_b32 v38, v22, v10
v_and_b32 v39, v22, v11
s_waitcnt vmcnt(11)
s_nop 0
v_mfma_f32_16x16x32_bf16 v[44:47], v[36:39], v[72:75], v[44:47]
v_and_b32 v40, v23, v8
v_and_b32 v41, v23, v9
v_and_b32 v42, v23, v10
v_and_b32 v43, v23, v11
s_waitcnt vmcnt(10)
s_nop 0
v_mfma_f32_16x16x32_bf16 v[44:47], v[40:43], v[76:79], v[44:47]
v_and_b32 v36, v24, v8
v_and_b32 v37, v24, v9
v_and_b32 v38, v24, v10
v_and_b32 v39, v24, v11
s_waitcnt vmcnt(9)
s_nop 0
v_mfma_f32_16x16x32_bf16 v[44:47], v[36:39], v[80:83], v[44:47]
v_and_b32 v40, v25, v8
v_and_b32 v41, v25, v9
v_and_b32 v42, v25, v10
v_and_b32 v43, v25, v11
s_waitcnt vmcnt(8)
s_nop 0
v_mfma_f32_16x16x32_bf16 v[44:47], v[40:43], v[84:87], v[44:47]
v_and_b32 v36, v26, v8
v_and_b32 v37, v26, v9
v_and_b32 v38, v26, v10
v_and_b32 v39, v26, v11
s_waitcnt vmcnt(7)
s_nop 0
v_mfma_f32_16x16x32_bf16 v[44:47], v[36:39], v[88:91], v[44:47]
v_and_b32 v40, v27, v8
v_and_b32 v41, v27, v9
v_and_b32 v42, v27, v10
v_and_b32 v43, v27, v11
s_waitcnt vmcnt(6)
s_nop 0
v_mfma_f32_16x16x32_bf16 v[44:47], v[40:43], v[92:95], v[44:47]
v_and_b32 v36, v28, v8
v_and_b32 v37, v28, v9
v_and_b32 v38, v28, v10
v_and_b32 v39, v28, v11
s_waitcnt vmcnt(5)
s_nop 0
v_mfma_f32_16x16x32_bf16 v[44:47], v[36:39], v[96:99], v[44:47]
v_and_b32 v40, v29, v8
v_and_b32 v41, v29, v9
v_and_b32 v42, v29, v10
v_and_b32 v43, v29, v11
s_waitcnt vmcnt(4)
s_nop 0
v_mfma_f32_16x16x32_bf16 v[44:47], v[40:43], v[100:103], v[44:47]
v_and_b32 v36, v30, v8
v_and_b32 v37, v30, v9
v_and_b32 v38, v30, v10
v_and_b32 v39, v30, v11
s_waitcnt vmcnt(3)
s_nop 0
v_mfma_f32_16x16x32_bf16 v[44:47], v[36:39], v[104:107], v[44:47]
v_and_b32 v40, v31, v8
v_and_b32 v41, v31, v9
v_and_b32 v42, v31, v10
v_and_b32 v43, v31, v11
s_waitcnt vmcnt(2)
s_nop 0
v_mfma_f32_16x16x32_bf16 v[44:47], v[40:43], v[108:111], v[44:47]
v_and_b32 v36, v32, v8
v_and_b32 v37, v32, v9
v_and_b32 v38, v32, v10
v_and_b32 v39, v32, v11
s_waitcnt vmcnt(1)
s_nop 0
v_mfma_f32_16x16x32_bf16 v[44:47], v[36:39], v[112:115], v[44:47]
v_and_b32 v40, v33, v8
v_and_b32 v41, v33, v9
v_and_b32 v42, v33, v10
v_and_b32 v43, v33, v11
s_waitcnt vmcnt(0)
s_nop 0
v_mfma_f32_16x16x32_bf16 v[44:47], v[40:43], v[116:119], v[44:47]
v_mov_b32 v6, 1
s_nop 6
ds_write_b128 v18, v[44:47]
s_mov_b64 exec, 1
ds_add_rtn_u32 v5, v7, v6 offset:16
s_mov_b64 exec, -1
ds_read_b64 v[20:21], v19 offset:4096
ds_read_b64 v[22:23], v19 offset:4736
ds_read_b64 v[24:25], v19 offset:5120
ds_read_b64 v[26:27], v19 offset:5760
ds_read_b64 v[28:29], v19 offset:6144
ds_read_b64 v[30:31], v19 offset:6784
ds_read_b64 v[32:33], v19 offset:7168
ds_read_b64 v[34:35], v19 offset:7808
s_waitcnt lgkmcnt(0)
v_readfirstlane_b32 s7, v5
v_pk_add_f32 v[20:21], v[20:21], v[22:23]
v_pk_add_f32 v[24:25], v[24:25], v[26:27]
v_pk_add_f32 v[28:29], v[28:29], v[30:31]
v_pk_add_f32 v[32:33], v[32:33], v[34:35]
v_pk_add_f32 v[20:21], v[20:21], v[24:25]
v_pk_add_f32 v[28:29], v[28:29], v[32:33]
v_pk_add_f32 v[20:21], v[20:21], v[28:29]
s_cmp_lg_u32 s7, 3
s_cbranch_scc1 L_Pdone
v_cvt_pk_bf16_f32 v20, v20, v21
v_mov_b32 v21, s31
s_cmp_eq_u32 s25, 2
s_cbranch_scc0 L_s_272_slow
buffer_store_dwordx2 v[20:21], v4, s[16:19], s63 offen
s_branch L_s_272_done
L_s_272_slow:
buffer_store_dwordx2 v[20:21], v4, s[16:19], s63 offen sc1
L_s_272_done:
buffer_store_dword v21, v62, s[16:19], s26 offen sc1
s_branch L_Pdone
L_noP:
s_cmp_ge_u32 s2, 16
s_cbranch_scc1 L_nopf
s_getpc_b64 s[42:43]
L_pc:
s_sub_u32 s42, s42, L_pc-adaLN_cond__gqa_block_cached__swiglu_ffn__decode_kernel
s_subb_u32 s43, s43, 0
s_mul_i32 s7, s60, CODE_Q
v_lshl_add_u32 v5, v0, 4, s7
.rept CODE_Q/1024
global_load_dwordx4 v[20:23], v5, s[42:43]
v_add_u32 v5, 0x400, v5
.endr
L_nopf:
s_lshl_b32 s7, s60, 9
s_add_u32 s7, s7, 2048
v_lshl_add_u32 v16, v0, 3, s7
v_lshl_add_u32 v17, v1, 6, s7
s_lshl_b32 s7, s60, 10
s_add_u32 s7, s7, 4096
v_lshl_add_u32 v18, v0, 4, s7
v_bfe_u32 v5, v0, 2, 3
v_bfe_u32 v6, v0, 1, 1
v_lshl_add_u32 v5, v6, 4, v5
v_and_b32 v6, 1, v0
v_lshlrev_b32 v6, 3, v6
v_lshl_add_u32 v19, v5, 4, v6
v_lshlrev_b32 v4, 3, v0
v_cmp_lt_u32 vcc, 31, v0
s_nop 1
v_cndmask_b32 v4, v4, v3, vcc
v_and_b32 v6, 1, v0
v_lshlrev_b32 v6, 4, v6
v_mov_b32 v5, 0xffff
v_lshlrev_b32 v5, v6, v5
v_bfe_u32 v6, v0, 1, 2
v_cmp_eq_u32 vcc, 0, v6
s_nop 1
v_cndmask_b32 v8, 0, v5, vcc
v_cmp_eq_u32 vcc, 1, v6
s_nop 1
v_cndmask_b32 v9, 0, v5, vcc
v_cmp_eq_u32 vcc, 2, v6
s_nop 1
v_cndmask_b32 v10, 0, v5, vcc
v_cmp_eq_u32 vcc, 3, v6
s_nop 1
v_cndmask_b32 v11, 0, v5, vcc
s_waitcnt lgkmcnt(0)
s_mul_i32 s31, s31, 1664525
s_add_u32 s31, s31, 1013904223
s_xor_b32 s24, s24, s31
v_and_b32 v63, 31, v0
v_lshlrev_b32 v63, 2, v63
s_lshl_b32 s27, s4, 7
s_add_u32 s27, s27, 32768
s_cmp_lg_u32 s60, 0
s_cbranch_scc1 L_i_273
s_lshl_b32 s7, s5, 2
v_mov_b32 v5, s7
v_mov_b32 v6, s24
s_mov_b64 exec, 1
buffer_store_dword v6, v5, s[16:19], s27 offen
s_mov_b64 exec, -1
L_i_273:
L_Pdone:
s_mov_b32 s61, 1
s_cmp_lt_u32 s5, 14
s_cbranch_scc1 L_r_274
s_sub_u32 s62, s5, 14
s_lshl_b32 s62, s62, 3
s_add_u32 s62, s62, s4
s_cmp_lt_u32 s62, 28
s_cselect_b32 s61, 2, 0
s_cmp_ge_u32 s5, 24
s_cselect_b32 s61, 3, s61
s_cmp_eq_u32 s5, 18
s_cselect_b32 s61, 4, s61
s_sub_u32 s7, s62, 40
s_cmp_lt_u32 s7, 28
s_cselect_b32 s61, 5, s61
L_r_274:
s_cmp_lg_u32 s60, 0
s_cbranch_scc1 L_early
v_lshlrev_b32 v48, 4, v0
v_mov_b32 v40, -1
v_mov_b32 v41, -1
v_mov_b32 v42, -1
v_mov_b32 v43, -1
s_cmp_lg_u32 s61, 2
s_cbranch_scc1 L_rs2
s_mul_i32 s29, s62, 3584
s_add_u32 s29, s29, 729088
v_lshlrev_b32 v5, 3, v0
buffer_store_dwordx4 v[40:43], v48, s[16:19], s29 offen sc1
buffer_store_dwordx4 v[40:43], v48, s[16:19], s29 offen offset:1024 sc1
buffer_store_dwordx4 v[40:43], v48, s[16:19], s29 offen offset:2048 sc1
buffer_store_dwordx2 v[40:41], v5, s[16:19], s29 offen offset:3072 sc1
L_rs2:
s_lshl_b32 s28, s4, 11
s_add_u32 s28, s28, 16384
s_mov_b32 s30, 262144
L_w_275:
ds_read_b32 v5, v7 offset:12
s_waitcnt lgkmcnt(0)
v_readfirstlane_b32 s7, v5
s_cmp_ge_u32 s7, 64
s_cbranch_scc1 L_w_275_d
s_sleep 4
s_sub_u32 s30, s30, 1
s_cmp_lg_u32 s30, 0
s_cbranch_scc1 L_w_275
L_w_275_d:
s_mov_b32 s30, 262144
L_p_276:
buffer_load_dwordx4 v[20:23], v48, s[16:19], s28 offen sc1
buffer_load_dwordx4 v[24:27], v48, s[16:19], s28 offen offset:1024 sc1
s_waitcnt vmcnt(0)
s_mov_b64 exec, -1
v_cmp_ne_u32 vcc, s31, v21
v_cmp_ne_u32 s[100:101], s31, v23
s_or_b64 vcc, vcc, s[100:101]
v_cmp_ne_u32 s[100:101], s31, v25
s_or_b64 vcc, vcc, s[100:101]
v_cmp_ne_u32 s[100:101], s31, v27
s_or_b64 vcc, vcc, s[100:101]
s_cbranch_vccz L_p_276_d
s_sleep 4
s_mov_b64 exec, vcc
s_sub_u32 s30, s30, 1
s_cmp_lg_u32 s30, 0
s_cbranch_scc1 L_p_276
s_mov_b64 exec, -1
L_p_276_d:
v_lshlrev_b32 v6, 3, v0
v_add_u32 v6, 256, v6
ds_write2_b32 v6, v20, v22 offset0:0 offset1:1
ds_write2_b32 v6, v24, v26 offset0:128 offset1:129
v_mov_b32 v6, 1
s_mov_b64 exec, 1
ds_write_b32 v7, v6 offset:0
s_mov_b64 exec, -1
buffer_load_dword v20, v63, s[16:19], s27 offen sc1
s_waitcnt vmcnt(0)
v_cmp_ne_u32 vcc, s24, v20
s_cmp_eq_u64 vcc, 0
s_cselect_b32 s25, 2, 1
L_early:
v_lshrrev_b32 v5, 5, v0
v_bfe_u32 v6, v0, 3, 1
v_lshl_add_u32 v253, v5, 1, v6
v_bfe_u32 v254, v0, 4, 1
v_mov_b32 v250, v3
v_mov_b32 v251, v3
v_mov_b32 v252, v3
s_cmp_lg_u32 s61, 1
s_cbranch_scc1 L_early2
s_mov_b32 s8, s40
s_mov_b32 s9, s41
s_mov_b32 s10, 3670016
s_mov_b32 s11, 0x20000
s_and_b32 s64, s5, 1
s_lshl_b32 s66, s4, 1
s_add_u32 s66, s66, s64
s_lshl_b32 s66, s66, 8
s_lshl_b32 s7, s60, 6
s_add_u32 s66, s66, s7
s_mul_i32 s66, s66, 896
s_lshr_b32 s7, s5, 1
s_lshl_b32 s7, s7, 7
s_add_u32 s66, s66, s7
s_add_u32 s67, s66, 3584
s_add_u32 s68, s66, 28672
s_add_u32 s69, s66, 32256
v_lshl_add_u32 v250, v253, 3, v254
v_mul_u32_u24 v250, 896, v250
v_lshl_add_u32 v250, v2, 4, v250
buffer_load_dwordx4 v[64:67], v250, s[8:11], s66 offen offset:0 nt
s_waitcnt vmcnt(0)
buffer_load_dwordx4 v[68:71], v250, s[8:11], s68 offen offset:0 nt
s_waitcnt vmcnt(0)
buffer_load_dwordx4 v[72:75], v250, s[8:11], s66 offen offset:1792 nt
L_early2:
s_cmp_lg_u32 s61, 2
s_cbranch_scc1 L_early3
s_mov_b32 s8, s44
s_mov_b32 s9, s45
s_mov_b32 s10, 1605632
s_mov_b32 s11, 0x20000
s_mov_b32 s12, s46
s_mov_b32 s13, s47
s_mov_b32 s14, 1605632
s_mov_b32 s15, 0x20000
v_mad_u32_u24 v250, v253, 28, v254
v_mul_u32_u24 v250, 3584, v250
v_lshl_add_u32 v250, v2, 4, v250
s_mul_i32 s66, s60, 401408
s_lshl_b32 s7, s62, 7
s_add_u32 s66, s66, s7
s_add_u32 s67, s66, 7168
s_mov_b32 s68, s66
s_mov_b32 s69, s67
s_cmp_eq_u32 s60, 0
s_cselect_b64 vcc, -1, 0
s_mov_b32 s20, s32
s_mov_b32 s21, s33
s_mov_b32 s22, 896
s_mov_b32 s23, 0x20000
v_lshrrev_b32 v5, 5, v0
v_bfe_u32 v6, v0, 3, 2
v_mad_u32_u24 v6, v6, 7, v2
v_cmp_ne_u32 s[98:99], 7, v2
s_mul_i32 s7, s60, 112
v_lshl_add_u32 v12, v6, 2, s7
v_mul_u32_u24 v13, 1792, v5
v_lshl_add_u32 v13, v12, 2, v13
v_cndmask_b32 v13, v3, v13, s[98:99]
v_lshl_add_u32 v12, v5, 1, v12
v_lshlrev_b32 v14, 1, v12
v_lshlrev_b32 v15, 2, v12
v_add_u32 v184, 20736, v15
v_cndmask_b32 v14, v3, v14, s[98:99]
v_cndmask_b32 v15, v3, v15, s[98:99]
v_mov_b32 v16, 22528
v_cndmask_b32 v184, v16, v184, s[98:99]
s_mov_b32 s28, 7680
s_lshl_b32 s7, s62, 4
v_and_b32 v61, 3, v0
v_lshlrev_b32 v61, 2, v61
v_lshrrev_b32 v5, 4, v0
v_add3_u32 v61, v61, v5, s7
v_lshrrev_b32 v62, 1, v61
v_lshlrev_b32 v62, 3, v62
s_mov_b32 s29, 13056
s_mov_b32 s30, 262144
L_w_277:
ds_read_b32 v5, v7 offset:0
s_waitcnt lgkmcnt(0)
v_readfirstlane_b32 s7, v5
s_cmp_ge_u32 s7, 1
s_cbranch_scc1 L_w_277_d
s_sleep 8
s_sub_u32 s30, s30, 1
s_cmp_lg_u32 s30, 0
s_cbranch_scc1 L_w_277
L_w_277_d:
buffer_load_dword v52, v14, s[20:23], 0 offen
s_mov_b32 s30, 262144
L_p_278:
buffer_load_dwordx2 v[20:21], v15, s[16:19], s28 offen sc1
buffer_load_dwordx2 v[22:23], v15, s[16:19], s28 offen offset:1792 sc1
buffer_load_dwordx2 v[24:25], v15, s[16:19], s28 offen offset:3584 sc1
buffer_load_dwordx2 v[26:27], v62, s[16:19], s29 offen sc1
s_waitcnt vmcnt(0)
v_cmp_ne_u32 vcc, s31, v21
v_cmp_ne_u32 s[100:101], s31, v23
s_or_b64 vcc, vcc, s[100:101]
v_cmp_ne_u32 s[100:101], s31, v25
s_or_b64 vcc, vcc, s[100:101]
s_and_b64 vcc, vcc, s[98:99]
v_cmp_ne_u32 s[100:101], s31, v27
s_or_b64 vcc, vcc, s[100:101]
s_cbranch_vccz L_p_278_d
s_sleep 8
s_sub_u32 s30, s30, 1
s_cmp_lg_u32 s30, 0
s_cbranch_scc1 L_p_278
L_p_278_d:
v_lshlrev_b32 v176, 16, v52
v_and_b32 v177, 0xffff0000, v52
v_lshlrev_b32 v178, 16, v20
v_and_b32 v179, 0xffff0000, v20
v_lshlrev_b32 v182, 16, v22
v_and_b32 v183, 0xffff0000, v22
v_lshlrev_b32 v180, 16, v24
v_and_b32 v181, 0xffff0000, v24
v_add_f32 v180, 1.0, v180
v_add_f32 v181, 1.0, v181
v_cvt_pk_bf16_f32 v28, v180, v181
v_lshlrev_b32 v180, 16, v28
v_and_b32 v181, 0xffff0000, v28
v_and_b32 v28, 0xffff0000, v26
v_lshlrev_b32 v26, 16, v26
v_and_b32 v5, 1, v61
v_cmp_eq_u32 vcc, 1, v5
s_nop 1
v_cndmask_b32 v26, v26, v28, vcc
v_lshlrev_b32 v5, 3, v0
ds_write_b64 v5, v[26:27] offset:23040
L_early3:
s_cmp_lg_u32 s60, 1
s_cbranch_scc1 L_noctl
s_mov_b32 s90, 16314592
s_mov_b32 s91, 806619139
s_and_b32 s26, s2, 7
s_mul_i32 s26, s26, 5
s_lshr_b32 s29, s2, 3
s_add_u32 s29, s29, s26
s_and_b32 s29, s29, 31
s_lshl_b32 s29, s29, 10
s_add_u32 s29, s29, 98304
s_mov_b32 s94, 1
s_mov_b32 s30, 262144
L_w_279:
ds_read_b32 v5, v7 offset:64
s_waitcnt lgkmcnt(0)
v_readfirstlane_b32 s7, v5
s_cmp_ge_u32 s7, 2
s_cbranch_scc1 L_w_279_d
s_sleep 2
s_sub_u32 s30, s30, 1
s_cmp_lg_u32 s30, 0
s_cbranch_scc1 L_w_279
L_w_279_d:
s_atomic_add s94, s[58:59], s29 glc
s_waitcnt lgkmcnt(0)
s_min_u32 s7, s94, 7
s_lshl_b32 s7, s7, 3
s_lshr_b64 s[92:93], s[90:91], s7
s_sext_i32_i8 s7, s92
s_mul_i32 s7, s7, 20
s_ashr_i32 s7, s7, 4
s_min_i32 s7, s7, 40
s_max_i32 s7, s7, -40
v_mov_b32 v6, s7
s_mov_b64 exec, 1
ds_write_b32 v7, v6 offset:128
s_mov_b64 exec, -1
s_mov_b32 s90, 16314592
s_mov_b32 s91, 806619139
s_and_b32 s26, s2, 7
s_mul_i32 s26, s26, 9
s_lshr_b32 s29, s2, 3
s_add_u32 s29, s29, s26
s_and_b32 s29, s29, 31
s_lshl_b32 s29, s29, 10
s_add_u32 s29, s29, 98564
s_mov_b32 s94, 1
s_mov_b32 s30, 262144
L_w_280:
ds_read_b32 v5, v7 offset:68
s_waitcnt lgkmcnt(0)
v_readfirstlane_b32 s7, v5
s_cmp_ge_u32 s7, 2
s_cbranch_scc1 L_w_280_d
s_sleep 2
s_sub_u32 s30, s30, 1
s_cmp_lg_u32 s30, 0
s_cbranch_scc1 L_w_280
L_w_280_d:
s_atomic_add s94, s[58:59], s29 glc
s_waitcnt lgkmcnt(0)
s_min_u32 s7, s94, 7
s_lshl_b32 s7, s7, 3
s_lshr_b64 s[92:93], s[90:91], s7
s_sext_i32_i8 s7, s92
s_mul_i32 s7, s7, 16
s_ashr_i32 s7, s7, 4
s_min_i32 s7, s7, 40
s_max_i32 s7, s7, -40
v_mov_b32 v6, s7
s_mov_b64 exec, 1
ds_write_b32 v7, v6 offset:132
s_mov_b64 exec, -1
s_mov_b32 s90, 16314592
s_mov_b32 s91, 806619139
s_and_b32 s26, s2, 7
s_mul_i32 s26, s26, 3
s_lshr_b32 s29, s2, 3
s_add_u32 s29, s29, s26
s_and_b32 s29, s29, 31
s_lshl_b32 s29, s29, 10
s_add_u32 s29, s29, 98824
s_mov_b32 s94, 1
s_mov_b32 s30, 262144
L_w_281:
ds_read_b32 v5, v7 offset:72
s_waitcnt lgkmcnt(0)
v_readfirstlane_b32 s7, v5
s_cmp_ge_u32 s7, 2
s_cbranch_scc1 L_w_281_d
s_sleep 2
s_sub_u32 s30, s30, 1
s_cmp_lg_u32 s30, 0
s_cbranch_scc1 L_w_281
L_w_281_d:
s_atomic_add s94, s[58:59], s29 glc
s_waitcnt lgkmcnt(0)
s_min_u32 s7, s94, 7
s_lshl_b32 s7, s7, 3
s_lshr_b64 s[92:93], s[90:91], s7
s_sext_i32_i8 s7, s92
s_mul_i32 s7, s7, 12
s_ashr_i32 s7, s7, 4
s_min_i32 s7, s7, 40
s_max_i32 s7, s7, -40
v_mov_b32 v6, s7
s_mov_b64 exec, 1
ds_write_b32 v7, v6 offset:136
s_mov_b64 exec, -1
s_mov_b32 s90, 16314592
s_mov_b32 s91, 806619139
s_and_b32 s26, s2, 7
s_mul_i32 s26, s26, 13
s_lshr_b32 s29, s2, 3
s_add_u32 s29, s29, s26
s_and_b32 s29, s29, 31
s_lshl_b32 s29, s29, 10
s_add_u32 s29, s29, 99084
s_mov_b32 s94, 1
s_mov_b32 s30, 262144
L_w_282:
ds_read_b32 v5, v7 offset:76
s_waitcnt lgkmcnt(0)
v_readfirstlane_b32 s7, v5
s_cmp_ge_u32 s7, 2
s_cbranch_scc1 L_w_282_d
s_sleep 2
s_sub_u32 s30, s30, 1
s_cmp_lg_u32 s30, 0
s_cbranch_scc1 L_w_282
L_w_282_d:
s_atomic_add s94, s[58:59], s29 glc
s_waitcnt lgkmcnt(0)
s_min_u32 s7, s94, 7
s_lshl_b32 s7, s7, 3
s_lshr_b64 s[92:93], s[90:91], s7
s_sext_i32_i8 s7, s92
s_mul_i32 s7, s7, 8
s_ashr_i32 s7, s7, 4
s_min_i32 s7, s7, 40
s_max_i32 s7, s7, -40
v_mov_b32 v6, s7
s_mov_b64 exec, 1
ds_write_b32 v7, v6 offset:140
s_mov_b64 exec, -1
s_mov_b32 s90, 16314592
s_mov_b32 s91, 806619139
s_and_b32 s26, s2, 7
s_mul_i32 s26, s26, 7
s_lshr_b32 s29, s2, 3
s_add_u32 s29, s29, s26
s_and_b32 s29, s29, 31
s_lshl_b32 s29, s29, 10
s_add_u32 s29, s29, 98320
s_mov_b32 s94, 1
s_mov_b32 s30, 262144
L_w_283:
ds_read_b32 v5, v7 offset:80
s_waitcnt lgkmcnt(0)
v_readfirstlane_b32 s7, v5
s_cmp_ge_u32 s7, 2
s_cbranch_scc1 L_w_283_d
s_sleep 2
s_sub_u32 s30, s30, 1
s_cmp_lg_u32 s30, 0
s_cbranch_scc1 L_w_283
L_w_283_d:
s_atomic_add s94, s[58:59], s29 glc
s_waitcnt lgkmcnt(0)
s_min_u32 s7, s94, 7
s_lshl_b32 s7, s7, 3
s_lshr_b64 s[92:93], s[90:91], s7
s_sext_i32_i8 s7, s92
s_mul_i32 s7, s7, 5
s_ashr_i32 s7, s7, 4
s_min_i32 s7, s7, 40
s_max_i32 s7, s7, -40
v_mov_b32 v6, s7
s_mov_b64 exec, 1
ds_write_b32 v7, v6 offset:144
s_mov_b64 exec, -1
s_mov_b32 s90, 16314592
s_mov_b32 s91, 806619139
s_and_b32 s26, s2, 7
s_mul_i32 s26, s26, 11
s_lshr_b32 s29, s2, 3
s_add_u32 s29, s29, s26
s_and_b32 s29, s29, 31
s_lshl_b32 s29, s29, 10
s_add_u32 s29, s29, 98580
s_mov_b32 s94, 1
s_mov_b32 s30, 262144
L_w_284:
ds_read_b32 v5, v7 offset:84
s_waitcnt lgkmcnt(0)
v_readfirstlane_b32 s7, v5
s_cmp_ge_u32 s7, 2
s_cbranch_scc1 L_w_284_d
s_sleep 2
s_sub_u32 s30, s30, 1
s_cmp_lg_u32 s30, 0
s_cbranch_scc1 L_w_284
L_w_284_d:
s_atomic_add s94, s[58:59], s29 glc
s_waitcnt lgkmcnt(0)
s_min_u32 s7, s94, 7
s_lshl_b32 s7, s7, 3
s_lshr_b64 s[92:93], s[90:91], s7
s_sext_i32_i8 s7, s92
s_mul_i32 s7, s7, 4
s_ashr_i32 s7, s7, 4
s_min_i32 s7, s7, 40
s_max_i32 s7, s7, -40
v_mov_b32 v6, s7
s_mov_b64 exec, 1
ds_write_b32 v7, v6 offset:148
s_mov_b64 exec, -1
L_noctl:
s_cmp_lg_u32 s60, 0
s_cbranch_scc1 L_tail
v_lshrrev_b32 v5, 5, v0
v_mul_u32_u24 v5, 4160, v5
v_and_b32 v6, 31, v0
v_lshl_add_u32 v60, v6, 4, v5
v_mov_b32 v62, 1035512379
v_lshlrev_b32 v61, 7, v6
v_lshlrev_b32 v247, 4, v0
s_lshl_b32 s28, s6, 7
s_add_u32 s28, s28, 65536
s_lshl_b32 s29, s4, 12
s_add_u32 s29, s29, 65536
s_mov_b32 s30, 262144
L_w_285:
ds_read_b32 v5, v7 offset:4
s_waitcnt lgkmcnt(0)
v_readfirstlane_b32 s7, v5
s_cmp_ge_u32 s7, 4
s_cbranch_scc1 L_w_285_d
s_sleep 4
s_sub_u32 s30, s30, 1
s_cmp_lg_u32 s30, 0
s_cbranch_scc1 L_w_285
L_w_285_d:
ds_read_b128 v[20:23], v60 offset:12288
ds_read_b128 v[24:27], v60 offset:12800
ds_read_b128 v[28:31], v60 offset:13312
ds_read_b128 v[32:35], v60 offset:13824
ds_read_b128 v[36:39], v60 offset:14336
ds_read_b128 v[40:43], v60 offset:14848
ds_read_b128 v[44:47], v60 offset:15360
ds_read_b128 v[48:51], v60 offset:15872
s_waitcnt lgkmcnt(7)
v_cvt_pk_bf16_f32 v5, v20, v21
v_lshlrev_b32 v20, 16, v5
v_and_b32 v21, 0xffff0000, v5
v_cvt_pk_bf16_f32 v6, v22, v23
v_lshlrev_b32 v22, 16, v6
v_and_b32 v23, 0xffff0000, v6
s_waitcnt lgkmcnt(6)
v_cvt_pk_bf16_f32 v5, v24, v25
v_lshlrev_b32 v24, 16, v5
v_and_b32 v25, 0xffff0000, v5
v_cvt_pk_bf16_f32 v6, v26, v27
v_lshlrev_b32 v26, 16, v6
v_and_b32 v27, 0xffff0000, v6
s_waitcnt lgkmcnt(5)
v_cvt_pk_bf16_f32 v5, v28, v29
v_lshlrev_b32 v28, 16, v5
v_and_b32 v29, 0xffff0000, v5
v_cvt_pk_bf16_f32 v6, v30, v31
v_lshlrev_b32 v30, 16, v6
v_and_b32 v31, 0xffff0000, v6
s_waitcnt lgkmcnt(4)
v_cvt_pk_bf16_f32 v5, v32, v33
v_lshlrev_b32 v32, 16, v5
v_and_b32 v33, 0xffff0000, v5
v_cvt_pk_bf16_f32 v6, v34, v35
v_lshlrev_b32 v34, 16, v6
v_and_b32 v35, 0xffff0000, v6
s_waitcnt lgkmcnt(3)
v_cvt_pk_bf16_f32 v5, v36, v37
v_lshlrev_b32 v36, 16, v5
v_and_b32 v37, 0xffff0000, v5
v_cvt_pk_bf16_f32 v6, v38, v39
v_lshlrev_b32 v38, 16, v6
v_and_b32 v39, 0xffff0000, v6
s_waitcnt lgkmcnt(2)
v_cvt_pk_bf16_f32 v5, v40, v41
v_lshlrev_b32 v40, 16, v5
v_and_b32 v41, 0xffff0000, v5
v_cvt_pk_bf16_f32 v6, v42, v43
v_lshlrev_b32 v42, 16, v6
v_and_b32 v43, 0xffff0000, v6
s_waitcnt lgkmcnt(1)
v_cvt_pk_bf16_f32 v5, v44, v45
v_lshlrev_b32 v44, 16, v5
v_and_b32 v45, 0xffff0000, v5
v_cvt_pk_bf16_f32 v6, v46, v47
v_lshlrev_b32 v46, 16, v6
v_and_b32 v47, 0xffff0000, v6
s_waitcnt lgkmcnt(0)
v_cvt_pk_bf16_f32 v5, v48, v49
v_lshlrev_b32 v48, 16, v5
v_and_b32 v49, 0xffff0000, v5
v_cvt_pk_bf16_f32 v6, v50, v51
v_lshlrev_b32 v50, 16, v6
v_and_b32 v51, 0xffff0000, v6
v_max_f32 v52, v20, v21
v_max3_f32 v52, v52, v22, v23
v_max3_f32 v52, v52, v24, v25
v_max3_f32 v52, v52, v26, v27
v_max3_f32 v52, v52, v28, v29
v_max3_f32 v52, v52, v30, v31
v_max3_f32 v52, v52, v32, v33
v_max3_f32 v52, v52, v34, v35
v_max3_f32 v52, v52, v36, v37
v_max3_f32 v52, v52, v38, v39
v_max3_f32 v52, v52, v40, v41
v_max3_f32 v52, v52, v42, v43
v_max3_f32 v52, v52, v44, v45
v_max3_f32 v52, v52, v46, v47
v_max3_f32 v52, v52, v48, v49
v_max3_f32 v52, v52, v50, v51
s_nop 1
v_max_f32_dpp v52, v52, v52 quad_perm:[1,0,3,2] row_mask:0xf bank_mask:0xf
s_nop 1
v_max_f32_dpp v52, v52, v52 quad_perm:[2,3,0,1] row_mask:0xf bank_mask:0xf
s_nop 1
v_max_f32_dpp v52, v52, v52 row_half_mirror row_mask:0xf bank_mask:0xf
s_nop 1
v_max_f32_dpp v52, v52, v52 row_mirror row_mask:0xf bank_mask:0xf
v_mov_b32 v53, v52
s_nop 1
v_permlane16_swap_b32 v52, v53
v_max_f32 v52, v52, v53
v_sub_f32 v20, v20, v52
v_sub_f32 v21, v21, v52
v_sub_f32 v22, v22, v52
v_sub_f32 v23, v23, v52
v_sub_f32 v24, v24, v52
v_sub_f32 v25, v25, v52
v_sub_f32 v26, v26, v52
v_sub_f32 v27, v27, v52
v_sub_f32 v28, v28, v52
v_sub_f32 v29, v29, v52
v_sub_f32 v30, v30, v52
v_sub_f32 v31, v31, v52
v_sub_f32 v32, v32, v52
v_sub_f32 v33, v33, v52
v_sub_f32 v34, v34, v52
v_sub_f32 v35, v35, v52
v_sub_f32 v36, v36, v52
v_sub_f32 v37, v37, v52
v_sub_f32 v38, v38, v52
v_sub_f32 v39, v39, v52
v_sub_f32 v40, v40, v52
v_sub_f32 v41, v41, v52
v_sub_f32 v42, v42, v52
v_sub_f32 v43, v43, v52
v_sub_f32 v44, v44, v52
v_sub_f32 v45, v45, v52
v_sub_f32 v46, v46, v52
v_sub_f32 v47, v47, v52
v_sub_f32 v48, v48, v52
v_sub_f32 v49, v49, v52
v_sub_f32 v50, v50, v52
v_sub_f32 v51, v51, v52
v_mul_f32 v20, v62, v20
v_mul_f32 v21, v62, v21
v_mul_f32 v22, v62, v22
v_mul_f32 v23, v62, v23
v_mul_f32 v24, v62, v24
v_mul_f32 v25, v62, v25
v_mul_f32 v26, v62, v26
v_mul_f32 v27, v62, v27
v_mul_f32 v28, v62, v28
v_mul_f32 v29, v62, v29
v_mul_f32 v30, v62, v30
v_mul_f32 v31, v62, v31
v_mul_f32 v32, v62, v32
v_mul_f32 v33, v62, v33
v_mul_f32 v34, v62, v34
v_mul_f32 v35, v62, v35
v_mul_f32 v36, v62, v36
v_mul_f32 v37, v62, v37
v_mul_f32 v38, v62, v38
v_mul_f32 v39, v62, v39
v_mul_f32 v40, v62, v40
v_mul_f32 v41, v62, v41
v_mul_f32 v42, v62, v42
v_mul_f32 v43, v62, v43
v_mul_f32 v44, v62, v44
v_mul_f32 v45, v62, v45
v_mul_f32 v46, v62, v46
v_mul_f32 v47, v62, v47
v_mul_f32 v48, v62, v48
v_mul_f32 v49, v62, v49
v_mul_f32 v50, v62, v50
v_mul_f32 v51, v62, v51
v_exp_f32 v20, v20
v_exp_f32 v21, v21
v_exp_f32 v22, v22
v_exp_f32 v23, v23
v_exp_f32 v24, v24
v_exp_f32 v25, v25
v_exp_f32 v26, v26
v_exp_f32 v27, v27
v_exp_f32 v28, v28
v_exp_f32 v29, v29
v_exp_f32 v30, v30
v_exp_f32 v31, v31
v_exp_f32 v32, v32
v_exp_f32 v33, v33
v_exp_f32 v34, v34
v_exp_f32 v35, v35
v_exp_f32 v36, v36
v_exp_f32 v37, v37
v_exp_f32 v38, v38
v_exp_f32 v39, v39
v_exp_f32 v40, v40
v_exp_f32 v41, v41
v_exp_f32 v42, v42
v_exp_f32 v43, v43
v_exp_f32 v44, v44
v_exp_f32 v45, v45
v_exp_f32 v46, v46
v_exp_f32 v47, v47
v_exp_f32 v48, v48
v_exp_f32 v49, v49
v_exp_f32 v50, v50
v_exp_f32 v51, v51
v_add_f32 v54, v20, v21
v_add_f32 v55, v22, v23
v_add_f32 v54, v54, v24
v_add_f32 v55, v55, v25
v_add_f32 v54, v54, v26
v_add_f32 v55, v55, v27
v_add_f32 v54, v54, v28
v_add_f32 v55, v55, v29
v_add_f32 v54, v54, v30
v_add_f32 v55, v55, v31
v_add_f32 v54, v54, v32
v_add_f32 v55, v55, v33
v_add_f32 v54, v54, v34
v_add_f32 v55, v55, v35
v_add_f32 v54, v54, v36
v_add_f32 v55, v55, v37
v_add_f32 v54, v54, v38
v_add_f32 v55, v55, v39
v_add_f32 v54, v54, v40
v_add_f32 v55, v55, v41
v_add_f32 v54, v54, v42
v_add_f32 v55, v55, v43
v_add_f32 v54, v54, v44
v_add_f32 v55, v55, v45
v_add_f32 v54, v54, v46
v_add_f32 v55, v55, v47
v_add_f32 v54, v54, v48
v_add_f32 v55, v55, v49
v_add_f32 v54, v54, v50
v_add_f32 v55, v55, v51
v_add_f32 v54, v54, v55
s_nop 1
v_add_f32_dpp v54, v54, v54 quad_perm:[1,0,3,2] row_mask:0xf bank_mask:0xf
s_nop 1
v_add_f32_dpp v54, v54, v54 quad_perm:[2,3,0,1] row_mask:0xf bank_mask:0xf
s_nop 1
v_add_f32_dpp v54, v54, v54 row_half_mirror row_mask:0xf bank_mask:0xf
s_nop 1
v_add_f32_dpp v54, v54, v54 row_mirror row_mask:0xf bank_mask:0xf
v_mov_b32 v53, v54
s_nop 1
v_permlane16_swap_b32 v54, v53
v_add_f32 v54, v54, v53
v_readlane_b32 s90, v52, 0
v_readlane_b32 s91, v52, 32
v_readlane_b32 s92, v54, 32
s_pack_hh_b32_b16 s90, s90, s91
v_mov_b32 v56, s90
v_mov_b32 v57, v54
v_mov_b32 v58, s92
v_mov_b32 v59, s31
s_waitcnt vmcnt(0)
s_mov_b64 exec, 0xff
s_cmp_eq_u32 s25, 2
s_cbranch_scc0 L_s_286_slow
buffer_store_dwordx4 v[56:59], v247, s[16:19], s28 offen
s_branch L_s_286_done
L_s_286_slow:
buffer_store_dwordx4 v[56:59], v247, s[16:19], s28 offen sc1
L_s_286_done:
s_mov_b64 exec, -1
s_mov_b32 s30, 262144
L_p_287:
buffer_load_dwordx4 v[240:243], v61, s[16:19], s29 offen sc1
s_waitcnt vmcnt(0)
s_mov_b64 exec, -1
v_cmp_ne_u32 vcc, s31, v243
s_cbranch_vccz L_p_287_d
s_sleep 8
s_mov_b64 exec, vcc
s_sub_u32 s30, s30, 1
s_cmp_lg_u32 s30, 0
s_cbranch_scc1 L_p_287
s_mov_b64 exec, -1
L_p_287_d:
v_lshlrev_b32 v244, 16, v240
v_and_b32 v245, 0xffff0000, v240
v_cmp_lt_u32 vcc, 31, v0
s_nop 1
v_cndmask_b32 v244, v244, v245, vcc
v_cndmask_b32 v241, v241, v242, vcc
v_mov_b32 v246, v244
s_nop 1
v_max_f32_dpp v246, v246, v246 quad_perm:[1,0,3,2] row_mask:0xf bank_mask:0xf
s_nop 1
v_max_f32_dpp v246, v246, v246 quad_perm:[2,3,0,1] row_mask:0xf bank_mask:0xf
s_nop 1
v_max_f32_dpp v246, v246, v246 row_half_mirror row_mask:0xf bank_mask:0xf
s_nop 1
v_max_f32_dpp v246, v246, v246 row_mirror row_mask:0xf bank_mask:0xf
v_mov_b32 v53, v246
s_nop 1
v_permlane16_swap_b32 v246, v53
v_max_f32 v246, v246, v53
v_sub_f32 v244, v244, v246
v_sub_f32 v52, v52, v246
v_mul_f32 v244, v62, v244
v_mul_f32 v52, v62, v52
v_exp_f32 v244, v244
v_exp_f32 v52, v52
v_mul_f32 v241, v241, v244
s_nop 1
v_add_f32_dpp v241, v241, v241 quad_perm:[1,0,3,2] row_mask:0xf bank_mask:0xf
s_nop 1
v_add_f32_dpp v241, v241, v241 quad_perm:[2,3,0,1] row_mask:0xf bank_mask:0xf
s_nop 1
v_add_f32_dpp v241, v241, v241 row_half_mirror row_mask:0xf bank_mask:0xf
s_nop 1
v_add_f32_dpp v241, v241, v241 row_mirror row_mask:0xf bank_mask:0xf
v_mov_b32 v53, v241
s_nop 1
v_permlane16_swap_b32 v241, v53
v_add_f32 v241, v241, v53
v_rcp_f32 v241, v241
s_nop 0
v_mul_f32 v52, v52, v241
v_mul_f32 v20, v52, v20
v_mul_f32 v21, v52, v21
v_mul_f32 v22, v52, v22
v_mul_f32 v23, v52, v23
v_cvt_pk_bf16_f32 v20, v20, v20
v_cvt_pk_bf16_f32 v21, v21, v21
v_cvt_pk_bf16_f32 v22, v22, v22
v_cvt_pk_bf16_f32 v23, v23, v23
ds_write_b128 v60, v[20:23] offset:12288
v_mul_f32 v24, v52, v24
v_mul_f32 v25, v52, v25
v_mul_f32 v26, v52, v26
v_mul_f32 v27, v52, v27
v_cvt_pk_bf16_f32 v24, v24, v24
v_cvt_pk_bf16_f32 v25, v25, v25
v_cvt_pk_bf16_f32 v26, v26, v26
v_cvt_pk_bf16_f32 v27, v27, v27
ds_write_b128 v60, v[24:27] offset:12800
v_mul_f32 v28, v52, v28
v_mul_f32 v29, v52, v29
v_mul_f32 v30, v52, v30
v_mul_f32 v31, v52, v31
v_cvt_pk_bf16_f32 v28, v28, v28
v_cvt_pk_bf16_f32 v29, v29, v29
v_cvt_pk_bf16_f32 v30, v30, v30
v_cvt_pk_bf16_f32 v31, v31, v31
ds_write_b128 v60, v[28:31] offset:13312
v_mul_f32 v32, v52, v32
v_mul_f32 v33, v52, v33
v_mul_f32 v34, v52, v34
v_mul_f32 v35, v52, v35
v_cvt_pk_bf16_f32 v32, v32, v32
v_cvt_pk_bf16_f32 v33, v33, v33
v_cvt_pk_bf16_f32 v34, v34, v34
v_cvt_pk_bf16_f32 v35, v35, v35
ds_write_b128 v60, v[32:35] offset:13824
v_mul_f32 v36, v52, v36
v_mul_f32 v37, v52, v37
v_mul_f32 v38, v52, v38
v_mul_f32 v39, v52, v39
v_cvt_pk_bf16_f32 v36, v36, v36
v_cvt_pk_bf16_f32 v37, v37, v37
v_cvt_pk_bf16_f32 v38, v38, v38
v_cvt_pk_bf16_f32 v39, v39, v39
ds_write_b128 v60, v[36:39] offset:14336
v_mul_f32 v40, v52, v40
v_mul_f32 v41, v52, v41
v_mul_f32 v42, v52, v42
v_mul_f32 v43, v52, v43
v_cvt_pk_bf16_f32 v40, v40, v40
v_cvt_pk_bf16_f32 v41, v41, v41
v_cvt_pk_bf16_f32 v42, v42, v42
v_cvt_pk_bf16_f32 v43, v43, v43
ds_write_b128 v60, v[40:43] offset:14848
v_mul_f32 v44, v52, v44
v_mul_f32 v45, v52, v45
v_mul_f32 v46, v52, v46
v_mul_f32 v47, v52, v47
v_cvt_pk_bf16_f32 v44, v44, v44
v_cvt_pk_bf16_f32 v45, v45, v45
v_cvt_pk_bf16_f32 v46, v46, v46
v_cvt_pk_bf16_f32 v47, v47, v47
ds_write_b128 v60, v[44:47] offset:15360
v_mul_f32 v48, v52, v48
v_mul_f32 v49, v52, v49
v_mul_f32 v50, v52, v50
v_mul_f32 v51, v52, v51
v_cvt_pk_bf16_f32 v48, v48, v48
v_cvt_pk_bf16_f32 v49, v49, v49
v_cvt_pk_bf16_f32 v50, v50, v50
v_cvt_pk_bf16_f32 v51, v51, v51
ds_write_b128 v60, v[48:51] offset:15872
v_mov_b32 v6, s25
s_mov_b64 exec, 1
ds_write_b32 v7, v6 offset:8
s_mov_b64 exec, -1
L_tail:
s_cmp_lg_u32 s61, 3
s_cbranch_scc1 L_noRclr
s_cmp_lg_u32 s60, 2
s_cbranch_scc1 L_noRclr
s_sub_u32 s7, s5, 24
s_lshl_b32 s7, s7, 2
s_lshl_b32 s72, s4, 5
s_add_u32 s7, s7, s72
s_mul_i32 s72, s7, 2176
s_add_u32 s72, s72, 131072
s_add_u32 s73, s72, 4352
s_lshl_b32 s63, s7, 5
s_add_u32 s63, s63, 688128
s_lshl_b32 s26, s7, 2
s_add_u32 s26, s26, 33792
v_lshlrev_b32 v13, 4, v0
v_cmp_gt_u32 vcc, 8, v0
s_nop 1
v_cndmask_b32 v14, v3, v13, vcc
v_mov_b32 v20, -1
v_mov_b32 v24, s31
v_mov_b32 v21, -1
v_mov_b32 v25, s31
v_mov_b32 v22, -1
v_mov_b32 v26, s31
v_mov_b32 v23, -1
v_mov_b32 v27, s31
s_mov_b32 s30, 262144
L_w_288:
ds_read_b32 v5, v7 offset:12
s_waitcnt lgkmcnt(0)
v_readfirstlane_b32 s7, v5
s_cmp_ge_u32 s7, 214
s_cbranch_scc1 L_w_288_d
s_sleep 4
s_sub_u32 s30, s30, 1
s_cmp_lg_u32 s30, 0
s_cbranch_scc1 L_w_288
L_w_288_d:
s_mov_b32 s30, 262144
L_w_289:
ds_read_b32 v5, v7 offset:8
s_waitcnt lgkmcnt(0)
v_readfirstlane_b32 s7, v5
s_cmp_ge_u32 s7, 1
s_cbranch_scc1 L_w_289_d
s_sleep 1
s_sub_u32 s30, s30, 1
s_cmp_lg_u32 s30, 0
s_cbranch_scc1 L_w_289
L_w_289_d:
s_mov_b32 s25, s7
s_cmp_eq_u32 s25, 2
s_cbranch_scc0 L_s_290_slow
buffer_store_dwordx4 v[20:23], v13, s[16:19], s72 offen offset:0
buffer_store_dwordx4 v[20:23], v13, s[16:19], s72 offen offset:1024
buffer_store_dwordx4 v[20:23], v13, s[16:19], s72 offen offset:2176
buffer_store_dwordx4 v[20:23], v13, s[16:19], s72 offen offset:3200
buffer_store_dwordx4 v[20:23], v13, s[16:19], s73 offen offset:0
buffer_store_dwordx4 v[20:23], v13, s[16:19], s73 offen offset:1024
buffer_store_dwordx4 v[20:23], v13, s[16:19], s73 offen offset:2176
buffer_store_dwordx4 v[20:23], v13, s[16:19], s73 offen offset:3200
buffer_store_dwordx4 v[20:23], v14, s[16:19], s63 offen
s_branch L_s_290_done
L_s_290_slow:
buffer_store_dwordx4 v[20:23], v13, s[16:19], s72 offen offset:0 sc1
buffer_store_dwordx4 v[20:23], v13, s[16:19], s72 offen offset:1024 sc1
buffer_store_dwordx4 v[20:23], v13, s[16:19], s72 offen offset:2176 sc1
buffer_store_dwordx4 v[20:23], v13, s[16:19], s72 offen offset:3200 sc1
buffer_store_dwordx4 v[20:23], v13, s[16:19], s73 offen offset:0 sc1
buffer_store_dwordx4 v[20:23], v13, s[16:19], s73 offen offset:1024 sc1
buffer_store_dwordx4 v[20:23], v13, s[16:19], s73 offen offset:2176 sc1
buffer_store_dwordx4 v[20:23], v13, s[16:19], s73 offen offset:3200 sc1
buffer_store_dwordx4 v[20:23], v14, s[16:19], s63 offen sc1
L_s_290_done:
s_waitcnt vmcnt(0)
s_mov_b64 exec, 1
s_cmp_eq_u32 s25, 2
s_cbranch_scc0 L_s_291_slow
buffer_store_dwordx4 v[24:27], v7, s[16:19], s26 offen
s_branch L_s_291_done
L_s_291_slow:
buffer_store_dwordx4 v[24:27], v7, s[16:19], s26 offen sc1
L_s_291_done:
s_mov_b64 exec, -1
L_noRclr:
s_cmp_eq_u32 s61, 2
s_cbranch_scc1 L_norw
s_cmp_lg_u32 s60, 3
s_cbranch_scc1 L_rw_292
s_add_u32 s27, s27, 1024
s_mov_b32 s30, 262144
L_w_293:
ds_read_b32 v5, v7 offset:12
s_waitcnt lgkmcnt(0)
v_readfirstlane_b32 s7, v5
s_cmp_ge_u32 s7, 232
s_cbranch_scc1 L_w_293_d
s_sleep 4
s_sub_u32 s30, s30, 1
s_cmp_lg_u32 s30, 0
s_cbranch_scc1 L_w_293
L_w_293_d:
s_mov_b32 s30, 262144
L_p_294:
buffer_load_dword v6, v63, s[16:19], s27 offen sc1
s_waitcnt vmcnt(0)
v_cmp_ne_u32 vcc, s31, v6
s_cbranch_vccz L_p_294_d
s_sleep 2
s_sub_u32 s30, s30, 1
s_cmp_lg_u32 s30, 0
s_cbranch_scc1 L_p_294
L_p_294_d:
v_mov_b32 v6, 1
s_mov_b64 exec, 1
ds_write_b32 v7, v6 offset:44
s_mov_b64 exec, -1
L_rw_292:
L_norw:
s_cmp_eq_u32 s61, 0
s_cbranch_scc1 L_helper_end
v_cmp_gt_u32 vcc, 4, v2
v_mov_b32 v5, 0xffff
s_nop 0
v_cndmask_b32 v8, 0, v5, vcc
v_xor_b32 v9, v5, v8
v_lshlrev_b32 v10, 16, v8
v_lshlrev_b32 v11, 16, v9
v_and_b32 v6, 3, v0
v_mul_u32_u24 v19, 0x5555, v6
v_lshlrev_b32 v245, 2, v0
v_lshrrev_b32 v5, 5, v0
v_lshlrev_b32 v244, 9, v5
v_lshl_add_u32 v244, v2, 5, v244
v_bfe_u32 v6, v0, 4, 1
v_lshl_add_u32 v244, v6, 4, v244
s_lshl_b32 s7, s60, 10
s_add_u32 s7, s7, 4096
v_add_u32 v244, s7, v244
s_mov_b32 s50, 0x00ff00ff
s_mov_b32 s51, 0xff00ff00
s_cmp_eq_u32 s61, 2
s_cbranch_scc1 L_T2
s_cmp_eq_u32 s61, 3
s_cbranch_scc1 L_R
s_cmp_eq_u32 s61, 4
s_cbranch_scc1 L_H
s_cmp_eq_u32 s61, 5
s_cbranch_scc1 L_F
s_mov_b32 s8, s40
s_mov_b32 s9, s41
s_mov_b32 s10, 3670016
s_mov_b32 s11, 0x20000
s_lshl_b32 s63, s4, 1
s_add_u32 s63, s63, s64
s_lshl_b32 s72, s63, 9
s_mul_i32 s63, s63, 1792
s_lshr_b32 s7, s5, 1
s_lshl_b32 s7, s7, 8
s_add_u32 s63, s63, s7
s_add_u32 s63, s63, 696320
s_lshl_b32 s7, s60, 7
s_add_u32 s72, s72, s7
s_add_u32 s72, s72, 688128
v_lshlrev_b32 v13, 4, v1
v_lshlrev_b32 v4, 2, v0
v_mov_b32 v16, 1
v_mov_b32 v44, 0
v_mov_b32 v45, 0
v_mov_b32 v46, 0
v_mov_b32 v47, 0
s_mov_b32 s30, 262144
L_w_295:
ds_read_b32 v5, v7 offset:28
s_waitcnt lgkmcnt(0)
v_readfirstlane_b32 s7, v5
s_cmp_ge_u32 s7, 4
s_cbranch_scc1 L_w_295_d
s_sleep 2
s_sub_u32 s30, s30, 1
s_cmp_lg_u32 s30, 0
s_cbranch_scc1 L_w_295
L_w_295_d:
buffer_load_dwordx4 v[76:79], v250, s[8:11], s68 offen offset:1792 nt
buffer_load_dwordx4 v[80:83], v250, s[8:11], s67 offen offset:0 nt
buffer_load_dwordx4 v[84:87], v250, s[8:11], s69 offen offset:0 nt
buffer_load_dwordx4 v[88:91], v250, s[8:11], s67 offen offset:1792 nt
buffer_load_dwordx4 v[92:95], v250, s[8:11], s69 offen offset:1792 nt
s_mov_b32 s30, 262144
L_w_296:
ds_read_b32 v5, v7 offset:44
s_waitcnt lgkmcnt(0)
v_readfirstlane_b32 s7, v5
s_cmp_ge_u32 s7, 1
s_cbranch_scc1 L_w_296_d
s_sleep 1
s_sub_u32 s30, s30, 1
s_cmp_lg_u32 s30, 0
s_cbranch_scc1 L_w_296
L_w_296_d:
s_mov_b32 s30, 262144
L_w_297:
ds_read_b32 v5, v7 offset:20
s_waitcnt lgkmcnt(0)
v_readfirstlane_b32 s7, v5
s_cmp_ge_u32 s7, 4
s_cbranch_scc1 L_w_297_d
s_sleep 1
s_sub_u32 s30, s30, 1
s_cmp_lg_u32 s30, 0
s_cbranch_scc1 L_w_297
L_w_297_d:
buffer_load_dwordx4 v[20:23], v13, s[16:19], s72 offen sc1
s_nop 15
buffer_load_dwordx4 v[20:23], v13, s[16:19], s72 offen sc1
s_nop 15
s_mov_b32 s30, 262144
L_p_298:
buffer_load_dwordx4 v[20:23], v13, s[16:19], s72 offen sc1
s_waitcnt vmcnt(2)
v_max3_u32 v24, v20, v21, v22
v_max_u32 v24, v24, v23
v_cmp_eq_u32 vcc, -1, v24
s_cbranch_vccz L_p_298_d
s_sub_u32 s30, s30, 1
s_cmp_lg_u32 s30, 0
s_cbranch_scc1 L_p_298
L_p_298_d:
v_and_b32 v36, v20, v8
v_and_b32 v37, v20, v9
v_and_b32 v38, v20, v10
v_and_b32 v39, v20, v11
v_and_b32 v40, v21, v8
v_and_b32 v41, v21, v9
v_and_b32 v42, v21, v10
v_and_b32 v43, v21, v11
v_smfmac_f32_16x16x64_bf16 v[44:47], v[36:39], v[64:71], v19
v_and_b32 v32, v22, v8
v_and_b32 v33, v22, v9
v_and_b32 v34, v22, v10
v_and_b32 v35, v22, v11
v_smfmac_f32_16x16x64_bf16 v[44:47], v[40:43], v[72:79], v19
v_and_b32 v36, v23, v8
v_and_b32 v37, v23, v9
v_and_b32 v38, v23, v10
v_and_b32 v39, v23, v11
v_smfmac_f32_16x16x64_bf16 v[44:47], v[32:35], v[80:87], v19
s_nop 0
v_smfmac_f32_16x16x64_bf16 v[44:47], v[36:39], v[88:95], v19
s_mov_b64 exec, s[50:51]
s_nop 6
ds_write_b128 v244, v[44:47]
s_mov_b64 exec, 1
ds_add_rtn_u32 v5, v7, v16 offset:24
s_mov_b64 exec, -1
ds_read2st64_b32 v[24:25], v245 offset0:16 offset1:18
ds_read2st64_b32 v[26:27], v245 offset0:20 offset1:22
ds_read2st64_b32 v[28:29], v245 offset0:24 offset1:26
ds_read2st64_b32 v[30:31], v245 offset0:28 offset1:30
s_waitcnt lgkmcnt(0)
v_readfirstlane_b32 s7, v5
v_pk_add_f32 v[24:25], v[24:25], v[26:27]
v_pk_add_f32 v[28:29], v[28:29], v[30:31]
v_pk_add_f32 v[24:25], v[24:25], v[28:29]
s_cmp_lg_u32 s7, 3
v_add_f32 v24, v24, v25
s_cbranch_scc1 L_helper_end
buffer_store_dword v24, v4, s[16:19], s63 offen sc1
L_helper_end:
s_endpgm
.p2align 6
L_R:
s_sub_u32 s7, s5, 24
s_lshl_b32 s7, s7, 2
s_add_u32 s7, s7, s60
s_lshl_b32 s72, s4, 5
s_add_u32 s7, s7, s72
s_mul_i32 s72, s7, 2176
s_add_u32 s72, s72, 131072
s_lshl_b32 s63, s7, 5
s_add_u32 s63, s63, 688128
s_bfe_u32 s70, s7, 0x20003
s_lshl_b32 s70, s70, 3
s_add_u32 s70, s70, s4
s_lshl_b32 s70, s70, 3
s_and_b32 s7, s7, 7
s_add_u32 s70, s70, s7
s_mul_i32 s70, s70, 7168
s_add_u32 s71, s70, 4096
s_mov_b32 s20, s48
s_mov_b32 s21, s49
s_mov_b32 s22, 1605632
s_mov_b32 s23, 0x20000
v_lshlrev_b32 v13, 4, v0
v_and_b32 v4, 3, v0
v_lshlrev_b32 v4, 3, v4
v_lshrrev_b32 v5, 5, v0
v_lshl_add_u32 v4, v5, 2, v4
v_bfe_u32 v5, v0, 2, 3
v_cmp_ne_u32 vcc, 0, v5
s_nop 1
v_cndmask_b32 v4, v4, v3, vcc
s_mov_b32 s30, 262144
L_w_299:
ds_read_b32 v5, v7 offset:44
s_waitcnt lgkmcnt(0)
v_readfirstlane_b32 s7, v5
s_cmp_ge_u32 s7, 1
s_cbranch_scc1 L_w_299_d
s_sleep 4
s_sub_u32 s30, s30, 1
s_cmp_lg_u32 s30, 0
s_cbranch_scc1 L_w_299
L_w_299_d:
s_mov_b32 s30, 262144
L_w_300:
ds_read_b32 v5, v7 offset:8
s_waitcnt lgkmcnt(0)
v_readfirstlane_b32 s7, v5
s_cmp_ge_u32 s7, 1
s_cbranch_scc1 L_w_300_d
s_sleep 1
s_sub_u32 s30, s30, 1
s_cmp_lg_u32 s30, 0
s_cbranch_scc1 L_w_300
L_w_300_d:
s_mov_b32 s25, s7
s_mov_b32 s30, 262144
L_w_301:
ds_read_b32 v5, v7 offset:28
s_waitcnt lgkmcnt(0)
v_readfirstlane_b32 s7, v5
s_cmp_ge_u32 s7, 4
s_cbranch_scc1 L_w_301_d
s_sleep 2
s_sub_u32 s30, s30, 1
s_cmp_lg_u32 s30, 0
s_cbranch_scc1 L_w_301
L_w_301_d:
buffer_load_dwordx4 v[20:23], v13, s[16:19], s72 offen sc1 nt
buffer_load_dwordx4 v[24:27], v13, s[16:19], s72 offen offset:1024 sc1 nt
s_mov_b32 s30, 262144
L_w_302:
ds_read_b32 v5, v7 offset:20
s_waitcnt lgkmcnt(0)
v_readfirstlane_b32 s7, v5
s_cmp_ge_u32 s7, 2
s_cbranch_scc1 L_w_302_d
s_sleep 1
s_sub_u32 s30, s30, 1
s_cmp_lg_u32 s30, 0
s_cbranch_scc1 L_w_302
L_w_302_d:
buffer_load_dwordx4 v[20:23], v13, s[16:19], s72 offen sc1
buffer_load_dwordx4 v[24:27], v13, s[16:19], s72 offen offset:1024 sc1
s_nop 15
s_nop 15
s_mov_b32 s30, 262144
L_p_303:
buffer_load_dwordx4 v[20:23], v13, s[16:19], s72 offen sc1
buffer_load_dwordx4 v[24:27], v13, s[16:19], s72 offen offset:1024 sc1
s_waitcnt vmcnt(2)
v_pk_add_f32 v[28:29], v[20:21], v[24:25]
v_pk_add_f32 v[30:31], v[22:23], v[26:27]
s_nop 1
v_permlane32_swap_b32 v28, v30
v_permlane32_swap_b32 v29, v31
v_pk_add_f32 v[28:29], v[28:29], v[30:31]
v_cmp_u_f32 vcc, v28, v29
s_cbranch_vccz L_p_303_d
s_sub_u32 s30, s30, 1
s_cmp_lg_u32 s30, 0
s_cbranch_scc1 L_p_303
L_p_303_d:
v_add_f32_dpp v28, v28, v28 row_ror:4 row_mask:0xf bank_mask:0xf
v_add_f32_dpp v29, v29, v29 row_ror:4 row_mask:0xf bank_mask:0xf
s_nop 0
v_add_f32_dpp v30, v28, v28 row_ror:8 row_mask:0xf bank_mask:0xf
v_add_f32_dpp v31, v29, v29 row_ror:8 row_mask:0xf bank_mask:0xf
v_add_f32_dpp v28, v28, v28 row_ror:8 row_mask:0xf bank_mask:0xf
v_add_f32_dpp v29, v29, v29 row_ror:8 row_mask:0xf bank_mask:0xf
s_nop 0
v_permlane16_swap_b32 v28, v30
v_permlane16_swap_b32 v29, v31
v_pk_add_f32 v[28:29], v[28:29], v[30:31]
v_cvt_pk_bf16_f32 v28, v28, v29
s_cmp_eq_u32 s25, 2
s_cbranch_scc0 L_s_304_slow
buffer_store_dword v28, v4, s[16:19], s63 offen
s_branch L_s_304_done
L_s_304_slow:
buffer_store_dword v28, v4, s[16:19], s63 offen sc1
L_s_304_done:
s_waitcnt vmcnt(0)
s_barrier
buffer_load_dwordx4 v[32:35], v13, s[20:23], s70 offen offset:0
buffer_load_dwordx4 v[32:35], v13, s[20:23], s70 offen offset:1024
buffer_load_dwordx4 v[32:35], v13, s[20:23], s70 offen offset:2048
buffer_load_dwordx4 v[32:35], v13, s[20:23], s70 offen offset:3072
buffer_load_dwordx4 v[32:35], v13, s[20:23], s71 offen offset:0
buffer_load_dwordx4 v[32:35], v13, s[20:23], s71 offen offset:1024
buffer_load_dwordx4 v[32:35], v13, s[20:23], s71 offen offset:2048
s_endpgm
.p2align 6
L_H:
s_cmp_lg_u32 s60, 2
s_cbranch_scc1 L_helper_end
s_lshl_b32 s72, s4, 10
s_add_u32 s72, s72, 688128
s_lshl_b32 s63, s4, 2
s_add_u32 s63, s63, 950272
s_add_u32 s65, s63, 4096
v_lshlrev_b32 v13, 4, v0
v_lshlrev_b32 v4, 6, v0
v_mov_b32 v16, s31
s_mul_i32 s73, s4, 69632
s_add_u32 s73, s73, 131072
v_lshrrev_b32 v5, 5, v0
v_mul_u32_u24 v5, 17408, v5
v_lshl_add_u32 v14, v63, 4, v5
s_mov_b32 s30, 262144
L_w_305:
ds_read_b32 v5, v7 offset:44
s_waitcnt lgkmcnt(0)
v_readfirstlane_b32 s7, v5
s_cmp_ge_u32 s7, 1
s_cbranch_scc1 L_w_305_d
s_sleep 4
s_sub_u32 s30, s30, 1
s_cmp_lg_u32 s30, 0
s_cbranch_scc1 L_w_305
L_w_305_d:
buffer_load_dwordx4 v[20:23], v13, s[16:19], s72 offen sc1
s_mov_b32 s30, 262144
L_w_306:
ds_read_b32 v5, v7 offset:20
s_waitcnt lgkmcnt(0)
v_readfirstlane_b32 s7, v5
s_cmp_ge_u32 s7, 4
s_cbranch_scc1 L_w_306_d
s_sleep 1
s_sub_u32 s30, s30, 1
s_cmp_lg_u32 s30, 0
s_cbranch_scc1 L_w_306
L_w_306_d:
buffer_load_dwordx4 v[20:23], v13, s[16:19], s72 offen sc1
s_nop 15
buffer_load_dwordx4 v[20:23], v13, s[16:19], s72 offen sc1
s_nop 15
s_mov_b32 s30, 262144
L_p_307:
buffer_load_dwordx4 v[20:23], v13, s[16:19], s72 offen sc1
s_waitcnt vmcnt(2)
v_max3_u32 v24, v20, v21, v22
v_max_u32 v24, v24, v23
v_cmp_eq_u32 vcc, -1, v24
s_cbranch_vccz L_p_307_d
s_sub_u32 s30, s30, 1
s_cmp_lg_u32 s30, 0
s_cbranch_scc1 L_p_307
L_p_307_d:
buffer_store_dword v16, v4, s[16:19], s63 offen sc1
buffer_store_dword v16, v4, s[16:19], s65 offen sc1
s_endpgm
.p2align 6
L_F:
s_mov_b32 s12, s46
s_mov_b32 s13, s47
s_mov_b32 s14, 1605632
s_mov_b32 s15, 0x20000
s_mov_b32 s20, s48
s_mov_b32 s21, s49
s_mov_b32 s22, 1605632
s_mov_b32 s23, 0x20000
s_sub_u32 s62, s62, 40
v_mad_u32_u24 v250, v253, 28, v254
v_mul_u32_u24 v250, 3584, v250
v_lshl_add_u32 v250, v2, 4, v250
s_mul_i32 s66, s60, 401408
s_lshl_b32 s7, s62, 7
s_add_u32 s66, s66, s7
s_add_u32 s67, s66, 7168
s_mov_b32 s68, s66
s_mov_b32 s69, s67
s_add_u32 s68, s68, 0
s_add_u32 s69, s69, 0
s_lshl_b32 s70, s62, 2
s_add_u32 s70, s70, s60
s_mul_i32 s70, s70, 14336
v_lshlrev_b32 v13, 4, v0
s_mov_b32 s30, 262144
L_w_308:
ds_read_b32 v5, v7 offset:28
s_waitcnt lgkmcnt(0)
v_readfirstlane_b32 s7, v5
s_cmp_ge_u32 s7, 4
s_cbranch_scc1 L_w_308_d
s_sleep 2
s_sub_u32 s30, s30, 1
s_cmp_lg_u32 s30, 0
s_cbranch_scc1 L_w_308
L_w_308_d:
buffer_load_dwordx4 v[120:123], v250, s[12:15], s68 offen
s_add_u32 s68, s68, 14336
buffer_load_dwordx4 v[124:127], v250, s[12:15], s69 offen
s_add_u32 s69, s69, 14336
buffer_load_dwordx4 v[128:131], v250, s[12:15], s68 offen
s_add_u32 s68, s68, 14336
buffer_load_dwordx4 v[132:135], v250, s[12:15], s69 offen
s_add_u32 s69, s69, 14336
buffer_load_dwordx4 v[136:139], v250, s[12:15], s68 offen
s_add_u32 s68, s68, 14336
s_mov_b32 s30, 262144
L_w_309:
ds_read_b32 v5, v7 offset:48
s_waitcnt lgkmcnt(0)
v_readfirstlane_b32 s7, v5
s_cmp_ge_u32 s7, 2
s_cbranch_scc1 L_w_309_d
s_sleep 1
s_sub_u32 s30, s30, 1
s_cmp_lg_u32 s30, 0
s_cbranch_scc1 L_w_309
L_w_309_d:
buffer_load_dwordx4 v[140:143], v250, s[12:15], s69 offen
s_add_u32 s69, s69, 14336
buffer_load_dwordx4 v[144:147], v250, s[12:15], s68 offen
s_add_u32 s68, s68, 14336
buffer_load_dwordx4 v[148:151], v250, s[12:15], s69 offen
s_add_u32 s69, s69, 14336
buffer_load_dwordx4 v[152:155], v250, s[12:15], s68 offen
s_add_u32 s68, s68, 14336
buffer_load_dwordx4 v[156:159], v250, s[12:15], s69 offen
s_add_u32 s69, s69, 14336
buffer_load_dwordx4 v[160:163], v250, s[12:15], s68 offen
s_add_u32 s68, s68, 14336
buffer_load_dwordx4 v[164:167], v250, s[12:15], s69 offen
s_add_u32 s69, s69, 14336
buffer_load_dwordx4 v[168:171], v250, s[12:15], s68 offen
s_add_u32 s68, s68, 14336
buffer_load_dwordx4 v[172:175], v250, s[12:15], s69 offen
s_add_u32 s69, s69, 14336
s_endpgm
.p2align 6
L_T2:
s_mov_b32 s8, s44
s_mov_b32 s9, s45
s_mov_b32 s10, 1605632
s_mov_b32 s11, 0x20000
s_mov_b32 s12, s46
s_mov_b32 s13, s47
s_mov_b32 s14, 1605632
s_mov_b32 s15, 0x20000
s_lshl_b32 s7, s60, 3
s_add_u32 s7, s7, 22784
v_bfe_u32 v6, v0, 4, 1
v_lshl_add_u32 v243, v6, 2, s7
s_lshl_b32 s7, s62, 2
s_add_u32 s7, s7, s60
s_lshl_b32 s7, s7, 6
s_add_u32 s7, s7, 950272
s_add_u32 s56, s58, s7
s_addc_u32 s57, s59, 0
v_mov_b32 v248, 991054117
v_mov_b32 v249, 991054117
s_mov_b32 s72, 696320
s_mov_b64 s[80:81], -1
s_mov_b32 s73, 699904
s_mov_b64 s[82:83], -1
s_mov_b32 s74, 703488
s_mov_b64 s[84:85], -1
s_mov_b32 s75, 707072
s_mov_b64 s[86:87], -1
s_mov_b32 s76, 710656
s_mov_b64 s[88:89], -1
s_mov_b32 s77, 714240
s_mov_b64 s[90:91], -1
s_mov_b32 s78, 717824
s_mov_b64 s[92:93], -1
s_mov_b32 s79, 721408
s_mov_b64 s[94:95], -1
s_waitcnt lgkmcnt(0)
v_mov_b32 v20, -1
v_mov_b32 v21, -1
v_mov_b32 v22, -1
v_mov_b32 v23, -1
v_mov_b32 v24, -1
v_mov_b32 v25, -1
v_mov_b32 v26, -1
v_mov_b32 v27, -1
v_mov_b32 v28, -1
v_mov_b32 v29, -1
v_mov_b32 v30, -1
v_mov_b32 v31, -1
v_mov_b32 v32, -1
v_mov_b32 v33, -1
v_mov_b32 v34, -1
v_mov_b32 v35, -1
v_mov_b32 v36, -1
v_mov_b32 v37, -1
v_mov_b32 v38, -1
v_mov_b32 v39, -1
v_mov_b32 v40, -1
v_mov_b32 v41, -1
v_mov_b32 v42, -1
v_mov_b32 v43, -1
v_mov_b32 v44, -1
v_mov_b32 v45, -1
v_mov_b32 v46, -1
v_mov_b32 v47, -1
v_mov_b32 v48, -1
v_mov_b32 v49, -1
v_mov_b32 v50, -1
v_mov_b32 v51, -1
s_cmp_lg_u32 s60, 3
s_cbranch_scc1 L_rw_310
s_add_u32 s27, s27, 1024
s_mov_b32 s30, 262144
L_w_311:
ds_read_b32 v5, v7 offset:12
s_waitcnt lgkmcnt(0)
v_readfirstlane_b32 s7, v5
s_cmp_ge_u32 s7, 232
s_cbranch_scc1 L_w_311_d
s_sleep 4
s_sub_u32 s30, s30, 1
s_cmp_lg_u32 s30, 0
s_cbranch_scc1 L_w_311
L_w_311_d:
s_mov_b32 s30, 262144
L_p_312:
buffer_load_dword v6, v63, s[16:19], s27 offen sc1
s_waitcnt vmcnt(0)
v_cmp_ne_u32 vcc, s31, v6
s_cbranch_vccz L_p_312_d
s_sleep 2
s_sub_u32 s30, s30, 1
s_cmp_lg_u32 s30, 0
s_cbranch_scc1 L_p_312
L_p_312_d:
v_mov_b32 v6, 1
s_mov_b64 exec, 1
ds_write_b32 v7, v6 offset:44
s_mov_b64 exec, -1
L_rw_310:
s_mov_b32 s30, 262144
L_w_313:
ds_read_b32 v5, v7 offset:28
s_waitcnt lgkmcnt(0)
v_readfirstlane_b32 s7, v5
s_cmp_ge_u32 s7, 4
s_cbranch_scc1 L_w_313_d
s_sleep 1
s_sub_u32 s30, s30, 1
s_cmp_lg_u32 s30, 0
s_cbranch_scc1 L_w_313
L_w_313_d:
buffer_load_dwordx4 v[64:67], v250, s[8:11], s66 offen nt
s_add_u32 s66, s66, 14336
buffer_load_dwordx4 v[68:71], v250, s[8:11], s67 offen nt
s_add_u32 s67, s67, 14336
buffer_load_dwordx4 v[72:75], v250, s[8:11], s66 offen nt
s_add_u32 s66, s66, 14336
buffer_load_dwordx4 v[76:79], v250, s[8:11], s67 offen nt
s_add_u32 s67, s67, 14336
buffer_load_dwordx4 v[80:83], v250, s[8:11], s66 offen nt
s_add_u32 s66, s66, 14336
s_mov_b32 s30, 262144
L_w_314:
ds_read_b32 v5, v7 offset:48
s_waitcnt lgkmcnt(0)
v_readfirstlane_b32 s7, v5
s_cmp_ge_u32 s7, 2
s_cbranch_scc1 L_w_314_d
s_sleep 1
s_sub_u32 s30, s30, 1
s_cmp_lg_u32 s30, 0
s_cbranch_scc1 L_w_314
L_w_314_d:
buffer_load_dwordx4 v[84:87], v250, s[8:11], s67 offen nt
s_add_u32 s67, s67, 14336
buffer_load_dwordx4 v[88:91], v250, s[8:11], s66 offen nt
s_add_u32 s66, s66, 14336
buffer_load_dwordx4 v[92:95], v250, s[8:11], s67 offen nt
s_add_u32 s67, s67, 14336
buffer_load_dwordx4 v[96:99], v250, s[8:11], s66 offen nt
s_add_u32 s66, s66, 14336
buffer_load_dwordx4 v[100:103], v250, s[8:11], s67 offen nt
s_add_u32 s67, s67, 14336
buffer_load_dwordx4 v[104:107], v250, s[8:11], s66 offen nt
s_add_u32 s66, s66, 14336
buffer_load_dwordx4 v[108:111], v250, s[8:11], s67 offen nt
s_add_u32 s67, s67, 14336
buffer_load_dwordx4 v[112:115], v250, s[8:11], s66 offen nt
s_add_u32 s66, s66, 14336
buffer_load_dwordx4 v[116:119], v250, s[8:11], s67 offen nt
s_add_u32 s67, s67, 14336
buffer_load_dwordx4 v[120:123], v250, s[12:15], s68 offen nt
s_add_u32 s68, s68, 14336
buffer_load_dwordx4 v[124:127], v250, s[12:15], s69 offen nt
s_add_u32 s69, s69, 14336
buffer_load_dwordx4 v[128:131], v250, s[12:15], s68 offen nt
s_add_u32 s68, s68, 14336
buffer_load_dwordx4 v[132:135], v250, s[12:15], s69 offen nt
s_add_u32 s69, s69, 14336
buffer_load_dwordx4 v[136:139], v250, s[12:15], s68 offen nt
s_add_u32 s68, s68, 14336
buffer_load_dwordx4 v[140:143], v250, s[12:15], s69 offen nt
s_add_u32 s69, s69, 14336
buffer_load_dwordx4 v[144:147], v250, s[12:15], s68 offen nt
s_add_u32 s68, s68, 14336
buffer_load_dwordx4 v[148:151], v250, s[12:15], s69 offen nt
s_add_u32 s69, s69, 14336
buffer_load_dwordx4 v[152:155], v250, s[12:15], s68 offen nt
s_add_u32 s68, s68, 14336
buffer_load_dwordx4 v[156:159], v250, s[12:15], s69 offen nt
s_add_u32 s69, s69, 14336
buffer_load_dwordx4 v[160:163], v250, s[12:15], s68 offen nt
s_add_u32 s68, s68, 14336
buffer_load_dwordx4 v[164:167], v250, s[12:15], s69 offen nt
s_add_u32 s69, s69, 14336
buffer_load_dwordx4 v[168:171], v250, s[12:15], s68 offen nt
s_add_u32 s68, s68, 14336
buffer_load_dwordx4 v[172:175], v250, s[12:15], s69 offen nt
s_add_u32 s69, s69, 14336
s_mov_b32 s30, 262144
s_mov_b32 s29, 0xff
v_mov_b32 v6, 1
L_h_315:
ds_read_b32 v5, v7 offset:56
s_sub_u32 s30, s30, 1
s_cbranch_scc1 L_h_315_all
s_waitcnt lgkmcnt(0)
v_readfirstlane_b32 s7, v5
s_and_b32 s7, s7, s29
s_cbranch_scc0 L_h_315
s_bitcmp0_b32 s7, 0
s_cbranch_scc0 L_h_315_f0
L_h_315_r0:
s_bitcmp0_b32 s7, 1
s_cbranch_scc0 L_h_315_f1
L_h_315_r1:
s_bitcmp0_b32 s7, 2
s_cbranch_scc0 L_h_315_f2
L_h_315_r2:
s_bitcmp0_b32 s7, 3
s_cbranch_scc0 L_h_315_f3
L_h_315_r3:
s_bitcmp0_b32 s7, 4
s_cbranch_scc0 L_h_315_f4
L_h_315_r4:
s_bitcmp0_b32 s7, 5
s_cbranch_scc0 L_h_315_f5
L_h_315_r5:
s_bitcmp0_b32 s7, 6
s_cbranch_scc0 L_h_315_f6
L_h_315_r6:
s_bitcmp0_b32 s7, 7
s_cbranch_scc0 L_h_315_f7
L_h_315_r7:
s_branch L_h_315
L_h_315_f0:
buffer_load_dwordx4 v[20:23], v13, s[16:19], s72 offen sc1
s_andn2_b32 s29, s29, 1
s_cbranch_scc1 L_h_315_r0
s_branch L_h_315_last
L_h_315_f1:
buffer_load_dwordx4 v[24:27], v13, s[16:19], s73 offen sc1
s_andn2_b32 s29, s29, 2
s_cbranch_scc1 L_h_315_r1
s_branch L_h_315_last
L_h_315_f2:
buffer_load_dwordx4 v[28:31], v13, s[16:19], s74 offen sc1
s_andn2_b32 s29, s29, 4
s_cbranch_scc1 L_h_315_r2
s_branch L_h_315_last
L_h_315_f3:
buffer_load_dwordx4 v[32:35], v13, s[16:19], s75 offen sc1
s_andn2_b32 s29, s29, 8
s_cbranch_scc1 L_h_315_r3
s_branch L_h_315_last
L_h_315_f4:
buffer_load_dwordx4 v[36:39], v13, s[16:19], s76 offen sc1
s_andn2_b32 s29, s29, 16
s_cbranch_scc1 L_h_315_r4
s_branch L_h_315_last
L_h_315_f5:
buffer_load_dwordx4 v[40:43], v13, s[16:19], s77 offen sc1
s_andn2_b32 s29, s29, 32
s_cbranch_scc1 L_h_315_r5
s_branch L_h_315_last
L_h_315_f6:
buffer_load_dwordx4 v[44:47], v13, s[16:19], s78 offen sc1
s_andn2_b32 s29, s29, 64
s_cbranch_scc1 L_h_315_r6
s_branch L_h_315_last
L_h_315_f7:
buffer_load_dwordx4 v[48:51], v13, s[16:19], s79 offen sc1
s_andn2_b32 s29, s29, 128
s_cbranch_scc1 L_h_315_r7
s_branch L_h_315_last
L_h_315_last:
s_mov_b64 exec, 1
ds_add_u32 v7, v6 offset:52
s_mov_b64 exec, -1
s_mov_b32 s30, 262143
s_branch L_h_315_chk
L_h_315_all:
s_mov_b32 s30, 262144
L_p_316:
s_cmp_eq_u64 s[80:81], 0
s_cbranch_scc1 L_p_316_s0
buffer_load_dwordx4 v[20:23], v13, s[16:19], s72 offen sc1
L_p_316_s0:
s_cmp_eq_u64 s[82:83], 0
s_cbranch_scc1 L_p_316_s1
buffer_load_dwordx4 v[24:27], v13, s[16:19], s73 offen sc1
L_p_316_s1:
s_cmp_eq_u64 s[84:85], 0
s_cbranch_scc1 L_p_316_s2
buffer_load_dwordx4 v[28:31], v13, s[16:19], s74 offen sc1
L_p_316_s2:
s_cmp_eq_u64 s[86:87], 0
s_cbranch_scc1 L_p_316_s3
buffer_load_dwordx4 v[32:35], v13, s[16:19], s75 offen sc1
L_p_316_s3:
s_cmp_eq_u64 s[88:89], 0
s_cbranch_scc1 L_p_316_s4
buffer_load_dwordx4 v[36:39], v13, s[16:19], s76 offen sc1
L_p_316_s4:
s_cmp_eq_u64 s[90:91], 0
s_cbranch_scc1 L_p_316_s5
buffer_load_dwordx4 v[40:43], v13, s[16:19], s77 offen sc1
L_p_316_s5:
s_cmp_eq_u64 s[92:93], 0
s_cbranch_scc1 L_p_316_s6
buffer_load_dwordx4 v[44:47], v13, s[16:19], s78 offen sc1
L_p_316_s6:
s_cmp_eq_u64 s[94:95], 0
s_cbranch_scc1 L_p_316_s7
buffer_load_dwordx4 v[48:51], v13, s[16:19], s79 offen sc1
L_p_316_s7:
L_h_315_chk:
s_waitcnt vmcnt(0)
v_pk_add_f32 v[60:61], v[20:21], v[24:25]
v_pk_add_f32 v[62:63], v[22:23], v[26:27]
v_pk_add_f32 v[60:61], v[60:61], v[28:29]
v_pk_add_f32 v[62:63], v[62:63], v[30:31]
v_pk_add_f32 v[60:61], v[60:61], v[32:33]
v_pk_add_f32 v[62:63], v[62:63], v[34:35]
v_pk_add_f32 v[60:61], v[60:61], v[36:37]
v_pk_add_f32 v[62:63], v[62:63], v[38:39]
v_pk_add_f32 v[60:61], v[60:61], v[40:41]
v_pk_add_f32 v[62:63], v[62:63], v[42:43]
v_pk_add_f32 v[60:61], v[60:61], v[44:45]
v_pk_add_f32 v[62:63], v[62:63], v[46:47]
v_pk_add_f32 v[60:61], v[60:61], v[48:49]
v_pk_add_f32 v[62:63], v[62:63], v[50:51]
s_nop 1
v_permlane32_swap_b32 v60, v62
v_permlane32_swap_b32 v61, v63
v_pk_add_f32 v[60:61], v[60:61], v[62:63]
v_cmp_u_f32 vcc, v60, v61
s_cbranch_vccz L_p_316_d
v_cmp_eq_u32 s[80:81], -1, v20
v_cmp_eq_u32 s[82:83], -1, v24
v_cmp_eq_u32 s[84:85], -1, v28
v_cmp_eq_u32 s[86:87], -1, v32
v_cmp_eq_u32 s[88:89], -1, v36
v_cmp_eq_u32 s[90:91], -1, v40
v_cmp_eq_u32 s[92:93], -1, v44
v_cmp_eq_u32 s[94:95], -1, v48
s_and_b32 s7, s30, 15
s_cbranch_scc1 L_p_316_k
s_mov_b32 s80, 1
s_mov_b32 s82, 1
s_mov_b32 s84, 1
s_mov_b32 s86, 1
s_mov_b32 s88, 1
s_mov_b32 s90, 1
s_mov_b32 s92, 1
s_mov_b32 s94, 1
L_p_316_k:
s_sub_u32 s30, s30, 1
s_cmp_lg_u32 s30, 0
s_cbranch_scc1 L_p_316
L_p_316_d:
v_cvt_pk_bf16_f32 v22, v60, v61
v_lshlrev_b32 v60, 16, v22
v_and_b32 v61, 0xffff0000, v22
v_pk_mul_f32 v[60:61], v[178:179], v[60:61]
v_cvt_pk_bf16_f32 v22, v60, v61
v_lshlrev_b32 v60, 16, v22
v_and_b32 v61, 0xffff0000, v22
v_pk_add_f32 v[52:53], v[176:177], v[60:61]
v_cvt_pk_bf16_f32 v22, v52, v53
v_lshlrev_b32 v52, 16, v22
v_and_b32 v53, 0xffff0000, v22
v_mul_f32 v25, v52, v52
v_add_f32 v24, v52, v53
v_fmac_f32 v25, v53, v53
ds_write_b64 v184, v[52:53]
v_mov_b32 v44, 0
v_permlane16_swap_b32 v24, v25
v_add_f32 v24, v24, v25
v_mov_b32 v45, 0
v_mov_b32 v46, 0
v_add_f32_dpp v24, v24, v24 quad_perm:[1,0,3,2] row_mask:0xf bank_mask:0xf
v_mov_b32 v47, 0
v_mov_b32 v48, 0
v_add_f32_dpp v24, v24, v24 quad_perm:[2,3,0,1] row_mask:0xf bank_mask:0xf
v_mov_b32 v49, 0
v_mov_b32 v50, 0
v_add_f32_dpp v24, v24, v24 row_half_mirror row_mask:0xf bank_mask:0xf
v_mov_b32 v51, 0
s_nop 0
v_add_f32_dpp v25, v24, v24 row_mirror row_mask:0xf bank_mask:0xf
v_add_f32_dpp v24, v24, v24 row_mirror row_mask:0xf bank_mask:0xf
s_nop 1
v_permlane32_swap_b32 v24, v25
v_add_f32 v24, v24, v25
s_mov_b64 exec, 0x10001
ds_write_b32 v243, v24
s_mov_b64 exec, -1
s_waitcnt lgkmcnt(0)
s_barrier
ds_read_b128 v[24:27], v7 offset:22784
ds_read_b128 v[28:31], v7 offset:22800
s_waitcnt lgkmcnt(1)
v_pk_add_f32 v[24:25], v[24:25], v[26:27]
s_waitcnt lgkmcnt(0)
v_pk_add_f32 v[28:29], v[28:29], v[30:31]
v_pk_add_f32 v[24:25], v[24:25], v[28:29]
v_pk_mul_f32 v[24:25], v[24:25], v[248:249]
v_fma_f32 v25, -v24, v24, v25
v_max_f32 v25, 0, v25
v_cvt_pk_bf16_f32 v22, v24, v25
v_and_b32 v26, 0xffff0000, v22
v_add_f32 v26, 925353388, v26
v_cvt_pk_bf16_f32 v26, v26, v26
v_lshlrev_b32 v26, 16, v26
v_sqrt_f32 v26, v26
v_lshlrev_b32 v24, 16, v22
v_cvt_pk_bf16_f32 v26, v26, v26
v_lshlrev_b32 v26, 16, v26
v_rcp_f32 v26, v26
v_pk_add_f32 v[52:53], v[52:53], v[24:25] op_sel_hi:[1,0] neg_lo:[0,1] neg_hi:[0,1]
v_cvt_pk_bf16_f32 v22, v52, v53
v_lshlrev_b32 v52, 16, v22
v_and_b32 v53, 0xffff0000, v22
v_pk_mul_f32 v[52:53], v[52:53], v[26:27] op_sel_hi:[1,0]
v_cvt_pk_bf16_f32 v22, v52, v53
v_lshlrev_b32 v52, 16, v22
v_and_b32 v53, 0xffff0000, v22
v_pk_mul_f32 v[52:53], v[52:53], v[180:181]
v_cvt_pk_bf16_f32 v22, v52, v53
v_lshlrev_b32 v52, 16, v22
v_and_b32 v53, 0xffff0000, v22
v_pk_add_f32 v[52:53], v[52:53], v[182:183]
v_cvt_pk_bf16_f32 v52, v52, v53
s_nop 1
v_mov_b32_dpp v53, v52 row_half_mirror row_mask:0xf bank_mask:0xf
v_and_b32_dpp v36, v52, v8 quad_perm:[0,0,0,0] row_mask:0xf bank_mask:0xf
v_and_b32_dpp v38, v52, v10 quad_perm:[0,0,0,0] row_mask:0xf bank_mask:0xf
v_and_b32_dpp v37, v53, v9 quad_perm:[3,3,3,3] row_mask:0xf bank_mask:0xf
v_and_b32_dpp v39, v53, v11 quad_perm:[3,3,3,3] row_mask:0xf bank_mask:0xf
v_and_b32_dpp v40, v52, v8 quad_perm:[1,1,1,1] row_mask:0xf bank_mask:0xf
v_and_b32_dpp v42, v52, v10 quad_perm:[1,1,1,1] row_mask:0xf bank_mask:0xf
v_smfmac_f32_16x16x64_bf16 v[44:47], v[36:39], v[64:71], v19
v_and_b32_dpp v41, v53, v9 quad_perm:[2,2,2,2] row_mask:0xf bank_mask:0xf
v_and_b32_dpp v43, v53, v11 quad_perm:[2,2,2,2] row_mask:0xf bank_mask:0xf
v_smfmac_f32_16x16x64_bf16 v[48:51], v[36:39], v[120:127], v19
v_and_b32_dpp v36, v52, v8 quad_perm:[2,2,2,2] row_mask:0xf bank_mask:0xf
v_and_b32_dpp v38, v52, v10 quad_perm:[2,2,2,2] row_mask:0xf bank_mask:0xf
v_smfmac_f32_16x16x64_bf16 v[44:47], v[40:43], v[72:79], v19
v_and_b32_dpp v37, v53, v9 quad_perm:[1,1,1,1] row_mask:0xf bank_mask:0xf
v_and_b32_dpp v39, v53, v11 quad_perm:[1,1,1,1] row_mask:0xf bank_mask:0xf
v_smfmac_f32_16x16x64_bf16 v[48:51], v[40:43], v[128:135], v19
v_and_b32_dpp v40, v52, v8 quad_perm:[3,3,3,3] row_mask:0xf bank_mask:0xf
v_and_b32_dpp v42, v52, v10 quad_perm:[3,3,3,3] row_mask:0xf bank_mask:0xf
v_smfmac_f32_16x16x64_bf16 v[44:47], v[36:39], v[80:87], v19
v_and_b32_dpp v41, v53, v9 quad_perm:[0,0,0,0] row_mask:0xf bank_mask:0xf
v_and_b32_dpp v43, v53, v11 quad_perm:[0,0,0,0] row_mask:0xf bank_mask:0xf
v_smfmac_f32_16x16x64_bf16 v[48:51], v[36:39], v[136:143], v19
v_and_b32_dpp v36, v53, v8 quad_perm:[3,3,3,3] row_mask:0xf bank_mask:0xf
v_and_b32_dpp v38, v53, v10 quad_perm:[3,3,3,3] row_mask:0xf bank_mask:0xf
v_smfmac_f32_16x16x64_bf16 v[44:47], v[40:43], v[88:95], v19
v_and_b32_dpp v37, v52, v9 quad_perm:[0,0,0,0] row_mask:0xf bank_mask:0xf
v_and_b32_dpp v39, v52, v11 quad_perm:[0,0,0,0] row_mask:0xf bank_mask:0xf
v_smfmac_f32_16x16x64_bf16 v[48:51], v[40:43], v[144:151], v19
v_and_b32_dpp v40, v53, v8 quad_perm:[2,2,2,2] row_mask:0xf bank_mask:0xf
v_and_b32_dpp v42, v53, v10 quad_perm:[2,2,2,2] row_mask:0xf bank_mask:0xf
v_smfmac_f32_16x16x64_bf16 v[44:47], v[36:39], v[96:103], v19
v_and_b32_dpp v41, v52, v9 quad_perm:[1,1,1,1] row_mask:0xf bank_mask:0xf
v_and_b32_dpp v43, v52, v11 quad_perm:[1,1,1,1] row_mask:0xf bank_mask:0xf
v_smfmac_f32_16x16x64_bf16 v[48:51], v[36:39], v[152:159], v19
v_and_b32_dpp v36, v53, v8 quad_perm:[1,1,1,1] row_mask:0xf bank_mask:0xf
v_and_b32_dpp v38, v53, v10 quad_perm:[1,1,1,1] row_mask:0xf bank_mask:0xf
v_smfmac_f32_16x16x64_bf16 v[44:47], v[40:43], v[104:111], v19
v_and_b32_dpp v37, v52, v9 quad_perm:[2,2,2,2] row_mask:0xf bank_mask:0xf
v_and_b32_dpp v39, v52, v11 quad_perm:[2,2,2,2] row_mask:0xf bank_mask:0xf
v_smfmac_f32_16x16x64_bf16 v[48:51], v[40:43], v[160:167], v19
s_nop 0
v_smfmac_f32_16x16x64_bf16 v[44:47], v[36:39], v[112:119], v19
v_smfmac_f32_16x16x64_bf16 v[48:51], v[36:39], v[168:175], v19
s_mov_b64 exec, s[50:51]
s_nop 5
ds_write_b128 v244, v[44:47]
ds_write_b128 v244, v[48:51] offset:256
s_mov_b64 exec, -1
s_waitcnt lgkmcnt(0)
s_barrier
s_endpgm
.p2align 6
L_D:
s_mov_b32 s20, s48
s_mov_b32 s21, s49
s_mov_b32 s22, 1605632
s_mov_b32 s23, 0x20000
s_mov_b32 s24, s54
s_mov_b32 s25, s55
s_mov_b32 s26, 896
s_mov_b32 s27, 0x20000
s_mov_b64 exec, -1
v_mov_b32 v3, 1073741824
v_and_b32 v2, 7, v0
v_cmp_gt_u32 vcc, 4, v2
v_mov_b32 v5, 0xffff
s_nop 0
v_cndmask_b32 v8, 0, v5, vcc
v_xor_b32 v9, v5, v8
v_lshlrev_b32 v10, 16, v8
v_lshlrev_b32 v11, 16, v9
v_and_b32 v6, 3, v0
v_mul_u32_u24 v19, 0x5555, v6
v_lshlrev_b32 v245, 2, v0
v_lshrrev_b32 v5, 5, v0
v_bfe_u32 v6, v0, 3, 1
v_cmp_ne_u32 vcc, v5, v6
v_lshl_add_u32 v253, v5, 1, v6
v_bfe_u32 v254, v0, 4, 1
v_lshrrev_b32 v247, 1, v2
v_mul_u32_u24 v247, 3584, v247
v_lshl_add_u32 v247, v5, 6, v247
v_and_b32 v6, 1, v0
v_lshl_add_u32 v247, v6, 5, v247
v_lshl_add_u32 v247, v254, 4, v247
v_cndmask_b32 v247, v247, v3, vcc
s_mul_i32 s63, s3, 28672
s_lshl_b32 s7, s69, 7
s_add_u32 s63, s63, s7
s_add_u32 s63, s63, 729088
s_add_u32 s65, s63, 14336
s_mov_b32 s18, 829440
v_mul_u32_u24 v5, 7, v254
v_lshl_add_u32 v5, v253, 3, v5
v_mul_u32_u24 v5, 896, v5
v_lshl_add_u32 v240, v2, 4, v5
v_mul_u32_u24 v5, 1792, v254
v_sub_u32 v5, 896, v5
v_add_u32 v241, v240, v5
v_add_u32 v242, v241, v5
v_add_u32 v243, v242, v5
s_mul_i32 s70, s69, 57344
s_lshl_b32 s7, s3, 8
s_add_u32 s70, s70, s7
s_add_u32 s71, s70, 28672
s_lshl_b32 s7, s69, 4
v_and_b32 v5, 3, v0
v_lshlrev_b32 v5, 2, v5
v_lshrrev_b32 v6, 4, v0
v_add3_u32 v5, v5, v6, s7
v_lshlrev_b32 v248, 2, v5
v_lshlrev_b32 v249, 1, v5
v_bfe_u32 v5, v0, 2, 2
v_cmp_ne_u32 vcc, 0, v5
s_nop 1
v_cndmask_b32 v249, v249, v3, vcc
v_lshlrev_b32 v250, 4, v0
v_cmp_lt_u32 vcc, 31, v0
s_nop 1
v_cndmask_b32 v251, v250, v3, vcc
v_lshlrev_b32 v5, 3, v0
s_mul_i32 s28, s69, 3584
s_add_u32 s28, s28, 729088
v_mov_b32 v56, 0
v_mov_b32 v57, 0
v_mov_b32 v58, 0
v_mov_b32 v59, 0
v_mov_b32 v60, 0
v_mov_b32 v61, 0
v_mov_b32 v62, 0
v_mov_b32 v63, 0
v_mov_b32 v184, 0
v_mov_b32 v185, 0
v_mov_b32 v186, 0
v_mov_b32 v187, 0
v_mov_b32 v188, 0
v_mov_b32 v189, 0
v_mov_b32 v190, 0
v_mov_b32 v191, 0
v_mov_b32 v200, 0
v_mov_b32 v201, 0
v_mov_b32 v202, 0
v_mov_b32 v203, 0
v_mov_b32 v204, 0
v_mov_b32 v205, 0
v_mov_b32 v206, 0
v_mov_b32 v207, 0
v_mov_b32 v216, 0
v_mov_b32 v217, 0
v_mov_b32 v218, 0
v_mov_b32 v219, 0
v_mov_b32 v220, 0
v_mov_b32 v221, 0
v_mov_b32 v222, 0
v_mov_b32 v223, 0
v_mov_b32 v232, 0
v_mov_b32 v233, 0
v_mov_b32 v234, 0
v_mov_b32 v235, 0
v_mov_b32 v236, 0
v_mov_b32 v237, 0
v_mov_b32 v238, 0
v_mov_b32 v239, 0
ds_read_b32 v6, v7 offset:23044
s_lshl_b32 s7, s69, 2
s_add_u32 s7, s7, s3
s_lshl_b32 s7, s7, 6
s_add_u32 s7, s7, 950272
s_add_u32 s56, s58, s7
s_addc_u32 s57, s59, 0
s_mov_b32 s30, 262144
s_mov_b32 s29, 0
s_waitcnt lgkmcnt(0)
v_readfirstlane_b32 s31, v6
s_mov_b64 exec, 1
L_dh_317:
s_load_dwordx8 s[40:47], s[56:57], 0 glc
s_sub_u32 s30, s30, 1
s_cbranch_scc1 L_dh_317_d
s_mov_b32 s7, 0
s_waitcnt lgkmcnt(0)
s_cmp_eq_u32 s47, s31
s_addc_u32 s7, s7, s7
s_cmp_eq_u32 s46, s31
s_addc_u32 s7, s7, s7
s_cmp_eq_u32 s45, s31
s_addc_u32 s7, s7, s7
s_cmp_eq_u32 s44, s31
s_addc_u32 s7, s7, s7
s_cmp_eq_u32 s43, s31
s_addc_u32 s7, s7, s7
s_cmp_eq_u32 s42, s31
s_addc_u32 s7, s7, s7
s_cmp_eq_u32 s41, s31
s_addc_u32 s7, s7, s7
s_cmp_eq_u32 s40, s31
s_addc_u32 s7, s7, s7
s_cmp_eq_u32 s7, s29
s_cbranch_scc1 L_dh_317
v_mov_b32 v6, s7
ds_or_b32 v7, v6 offset:56
s_mov_b32 s29, s7
s_cmpk_lg_u32 s7, 0xff
s_cbranch_scc1 L_dh_317
L_dh_317_d:
s_mov_b64 exec, -1
s_mov_b32 s30, 262144
L_w_318:
ds_read_b32 v6, v7 offset:52
s_waitcnt lgkmcnt(0)
v_readfirstlane_b32 s7, v6
s_cmp_ge_u32 s7, 4
s_cbranch_scc1 L_w_318_d
s_sleep 0
s_sub_u32 s30, s30, 1
s_cmp_lg_u32 s30, 0
s_cbranch_scc1 L_w_318
L_w_318_d:
buffer_load_dwordx4 v[176:179], v240, s[20:23], s70 offen offset:0 nt
buffer_load_dwordx4 v[180:183], v240, s[20:23], s71 offen offset:0 nt
buffer_load_dwordx4 v[192:195], v241, s[20:23], s70 offen offset:0 nt
buffer_load_dwordx4 v[196:199], v241, s[20:23], s71 offen offset:0 nt
buffer_load_dwordx4 v[208:211], v242, s[20:23], s70 offen offset:0 nt
buffer_load_dwordx4 v[212:215], v242, s[20:23], s71 offen offset:0 nt
buffer_load_dwordx4 v[224:227], v243, s[20:23], s70 offen offset:0 nt
buffer_load_dwordx4 v[228:231], v243, s[20:23], s71 offen offset:0 nt
s_barrier
s_cmp_eq_u32 s3, 3
s_cbranch_scc1 L_D3
buffer_load_dwordx4 v[184:187], v240, s[20:23], s70 offen offset:128 nt
buffer_load_dwordx4 v[188:191], v240, s[20:23], s71 offen offset:128 nt
buffer_load_dwordx4 v[200:203], v241, s[20:23], s70 offen offset:128 nt
buffer_load_dwordx4 v[204:207], v241, s[20:23], s71 offen offset:128 nt
buffer_load_dwordx4 v[216:219], v242, s[20:23], s70 offen offset:128 nt
buffer_load_dwordx4 v[220:223], v242, s[20:23], s71 offen offset:128 nt
buffer_load_dwordx4 v[232:235], v243, s[20:23], s70 offen offset:128 nt
buffer_load_dwordx4 v[236:239], v243, s[20:23], s71 offen offset:128 nt
L_D3:
ds_read_b32 v54, v248 offset:20736
ds_read_b64 v[52:53], v5 offset:23040
s_waitcnt lgkmcnt(0)
s_barrier
ds_read2st64_b32 v[20:21], v245 offset0:16 offset1:17
ds_read2st64_b32 v[22:23], v245 offset0:18 offset1:19
ds_read2st64_b32 v[24:25], v245 offset0:20 offset1:21
ds_read2st64_b32 v[26:27], v245 offset0:22 offset1:23
ds_read2st64_b32 v[28:29], v245 offset0:24 offset1:25
ds_read2st64_b32 v[30:31], v245 offset0:26 offset1:27
ds_read2st64_b32 v[32:33], v245 offset0:28 offset1:29
ds_read2st64_b32 v[34:35], v245 offset0:30 offset1:31
s_waitcnt lgkmcnt(6)
v_pk_add_f32 v[20:21], v[20:21], v[22:23]
s_waitcnt lgkmcnt(5)
v_pk_add_f32 v[20:21], v[20:21], v[24:25]
s_waitcnt lgkmcnt(4)
v_pk_add_f32 v[20:21], v[20:21], v[26:27]
s_waitcnt lgkmcnt(3)
v_pk_add_f32 v[20:21], v[20:21], v[28:29]
s_waitcnt lgkmcnt(2)
v_pk_add_f32 v[20:21], v[20:21], v[30:31]
s_waitcnt lgkmcnt(1)
v_pk_add_f32 v[20:21], v[20:21], v[32:33]
s_waitcnt lgkmcnt(0)
v_pk_add_f32 v[20:21], v[20:21], v[34:35]
v_cvt_pk_bf16_f32 v21, v20, v21
v_lshlrev_b32 v20, 16, v21
v_mul_f32 v22, 3216550459, v20
v_exp_f32 v22, v22
v_and_b32 v21, 0xffff0000, v21
v_add_f32 v22, 1.0, v22
v_rcp_f32 v22, v22
s_nop 0
v_mul_f32 v20, v20, v22
v_cvt_pk_bf16_f32 v20, v20, v20
v_lshlrev_b32 v20, 16, v20
v_mul_f32 v20, v20, v21
s_nop 1
v_mov_b32_dpp v21, v20 row_half_mirror row_mask:0xf bank_mask:0xf
v_cvt_pk_bf16_f32 v20, v20, v21
s_nop 1
v_and_b32_dpp v36, v20, v8 quad_perm:[0,0,0,0] row_mask:0xf bank_mask:0xf
v_and_b32_dpp v38, v20, v10 quad_perm:[0,0,0,0] row_mask:0xf bank_mask:0xf
v_and_b32_dpp v37, v20, v11 quad_perm:[3,3,3,3] row_mask:0xf bank_mask:0xf
v_and_b32_dpp v39, v20, v9 quad_perm:[3,3,3,3] row_mask:0xf bank_mask:0xf
v_and_b32_dpp v40, v20, v8 quad_perm:[1,1,1,1] row_mask:0xf bank_mask:0xf
v_and_b32_dpp v42, v20, v10 quad_perm:[1,1,1,1] row_mask:0xf bank_mask:0xf
s_waitcnt vmcnt(0)
v_smfmac_f32_16x16x64_bf16 v[56:59], v[36:39], v[176:183], v19
v_and_b32_dpp v41, v20, v11 quad_perm:[2,2,2,2] row_mask:0xf bank_mask:0xf
v_and_b32_dpp v43, v20, v9 quad_perm:[2,2,2,2] row_mask:0xf bank_mask:0xf
v_smfmac_f32_16x16x64_bf16 v[60:63], v[36:39], v[184:191], v19
v_and_b32_dpp v36, v20, v8 quad_perm:[2,2,2,2] row_mask:0xf bank_mask:0xf
v_and_b32_dpp v38, v20, v10 quad_perm:[2,2,2,2] row_mask:0xf bank_mask:0xf
v_smfmac_f32_16x16x64_bf16 v[56:59], v[40:43], v[192:199], v19
v_and_b32_dpp v37, v20, v11 quad_perm:[1,1,1,1] row_mask:0xf bank_mask:0xf
v_and_b32_dpp v39, v20, v9 quad_perm:[1,1,1,1] row_mask:0xf bank_mask:0xf
v_smfmac_f32_16x16x64_bf16 v[60:63], v[40:43], v[200:207], v19
v_and_b32_dpp v40, v20, v8 quad_perm:[3,3,3,3] row_mask:0xf bank_mask:0xf
v_and_b32_dpp v42, v20, v10 quad_perm:[3,3,3,3] row_mask:0xf bank_mask:0xf
v_smfmac_f32_16x16x64_bf16 v[56:59], v[36:39], v[208:215], v19
v_and_b32_dpp v41, v20, v11 quad_perm:[0,0,0,0] row_mask:0xf bank_mask:0xf
v_and_b32_dpp v43, v20, v9 quad_perm:[0,0,0,0] row_mask:0xf bank_mask:0xf
v_smfmac_f32_16x16x64_bf16 v[60:63], v[36:39], v[216:223], v19
s_nop 0
v_smfmac_f32_16x16x64_bf16 v[56:59], v[40:43], v[224:231], v19
v_smfmac_f32_16x16x64_bf16 v[60:63], v[40:43], v[232:239], v19
s_nop 6
buffer_store_dwordx4 v[56:59], v247, s[16:19], s63 offen sc1
s_cmp_eq_u32 s3, 3
s_cbranch_scc1 L_T3
buffer_store_dwordx4 v[60:63], v247, s[16:19], s65 offen sc1
s_endpgm
L_T3:
s_waitcnt vmcnt(0)
s_mov_b32 s30, 262144
L_p_319:
buffer_load_dwordx4 v[64:67], v250, s[16:19], s28 offen offset:0 sc1
buffer_load_dwordx4 v[68:71], v250, s[16:19], s28 offen offset:1024 sc1
buffer_load_dwordx4 v[72:75], v250, s[16:19], s28 offen offset:2048 sc1
buffer_load_dwordx4 v[76:79], v251, s[16:19], s28 offen offset:3072 sc1
s_waitcnt vmcnt(2)
v_pk_add_f32 v[20:21], v[64:65], v[68:69]
v_pk_add_f32 v[22:23], v[66:67], v[70:71]
s_waitcnt vmcnt(1)
v_pk_add_f32 v[20:21], v[20:21], v[72:73]
v_pk_add_f32 v[22:23], v[22:23], v[74:75]
s_waitcnt vmcnt(0)
v_pk_add_f32 v[20:21], v[20:21], v[76:77]
v_pk_add_f32 v[22:23], v[22:23], v[78:79]
s_nop 1
v_permlane32_swap_b32 v20, v22
v_permlane32_swap_b32 v21, v23
v_pk_add_f32 v[20:21], v[20:21], v[22:23]
v_cmp_u_f32 vcc, v20, v21
s_cbranch_vccz L_p_319_d
s_sub_u32 s30, s30, 1
s_cmp_lg_u32 s30, 0
s_cbranch_scc1 L_p_319
L_p_319_d:
v_permlane16_swap_b32 v20, v21
v_add_f32 v20, v20, v21
s_nop 1
v_add_f32_dpp v20, v20, v20 row_ror:4 row_mask:0xf bank_mask:0xf
s_nop 1
v_add_f32_dpp v20, v20, v20 row_ror:8 row_mask:0xf bank_mask:0xf
v_cvt_pk_bf16_f32 v20, v20, v20
v_lshlrev_b32 v20, 16, v20
v_mul_f32 v20, v52, v20
v_cvt_pk_bf16_f32 v20, v20, v20
v_lshlrev_b32 v20, 16, v20
v_add_f32 v20, v54, v20
v_cvt_pk_bf16_f32 v20, v20, v20
buffer_store_short v20, v249, s[24:27], 0 offen
s_cmp_lg_u32 s69, 0
s_cbranch_scc1 L_T3_end
s_mov_b64 exec, 1
buffer_store_dword v53, v7, s[16:19], 0 offen sc1
L_T3_end:
s_endpgm
L_exit:
s_endpgm
L_code_end:
.fill 1024, 4, 0xbf810000
.section .rodata,"a"
.p2align 6
.amdhsa_kernel adaLN_cond__gqa_block_cached__swiglu_ffn__decode_kernel
  .amdhsa_next_free_vgpr 256
  .amdhsa_next_free_sgpr 102
  .amdhsa_accum_offset 256
  .amdhsa_group_segment_fixed_size 0
  .amdhsa_kernarg_size 112
  .amdhsa_user_sgpr_count 2
  .amdhsa_user_sgpr_kernarg_segment_ptr 1
  .amdhsa_system_sgpr_workgroup_id_x 1
.end_amdhsa_kernel
```
